```python
import torch

def _softmax(x, axis=-1):
    return torch.softmax(x, dim=axis)
def _gelu(x):
    return torch.nn.functional.gelu(x, approximate="tanh")
def _silu(x):
    return torch.nn.functional.silu(x)
def _sigmoid(x):
    return torch.sigmoid(x)
def _layernorm(x, axis=-1, eps=1e-5):
    m = x.mean(dim=axis, keepdim=True)
    v = x.var(dim=axis, keepdim=True, unbiased=False)
    return (x - m) / torch.sqrt(v + eps)
def _scatter_add(tgt, idx, src, axis=0):
    return tgt.clone().index_add_(axis, idx, src)
def _segment_sum(src, seg, n):
    out = torch.zeros((n,) + src.shape[1:], dtype=src.dtype)
    return out.index_add_(0, seg, src)
def _pad(x, pw):
    flat = tuple(v for pair in reversed(pw) for v in pair)
    return torch.nn.functional.pad(x, flat)

kernel_name = 'concat_heads__gqa_block_cached__gqa_block_cached__near_ridge'

def setup_inputs():

    _w = (lambda a: (lambda t: t.to(torch.bfloat16) if t.is_floating_point() else t)(torch.as_tensor(a)))
    def _A_setup():
        B, Sq, D = 8, 48, 1024
        Hq, Hkv, Sk, Dh = 32, 4, 1024, 128
        assert Hq % Hkv == 0, (Hq, Hkv)
        return {
            "x": _w((lambda *s: torch.randn(*s, dtype=torch.bfloat16) * 0.8)(B, Sq, D)),
            "k_cache": _w((lambda *s: torch.randn(*s, dtype=torch.bfloat16) * 0.8)(B, Hkv, Sk, Dh)),
            "v_cache": _w((lambda *s: torch.randn(*s, dtype=torch.bfloat16) * 0.05)(B, Hkv, Sk, Dh)),
            "wq": _w((lambda *s: torch.randn(*s, dtype=torch.bfloat16) * 0.8)(D, Hq * Dh) * (D ** -0.5)),
            "wo": _w((lambda *s: torch.randn(*s, dtype=torch.bfloat16) * 0.05)(Hq * Dh, D) * ((Hq * Dh) ** -0.5)),
        }
    _A_in = _A_setup()

    def _B_setup():
        B, Sq, D = 8, 48, 1024
        Hq, Hkv, Sk, Dh = 32, 4, 1024, 128
        assert Hq % Hkv == 0, (Hq, Hkv)
        return {
            "x": _w((lambda *s: torch.randn(*s, dtype=torch.bfloat16) * 0.8)(B, Sq, D)),
            "k_cache": _w((lambda *s: torch.randn(*s, dtype=torch.bfloat16) * 0.8)(B, Hkv, Sk, Dh)),
            "v_cache": _w((lambda *s: torch.randn(*s, dtype=torch.bfloat16) * 0.05)(B, Hkv, Sk, Dh)),
            "wq": _w((lambda *s: torch.randn(*s, dtype=torch.bfloat16) * 0.8)(D, Hq * Dh) * (D ** -0.5)),
            "wo": _w((lambda *s: torch.randn(*s, dtype=torch.bfloat16) * 0.05)(Hq * Dh, D) * ((Hq * Dh) ** -0.5)),
        }
    _B_in = _B_setup()

    return {
        "A_x": _A_in["x"],
        "A_k_cache": _A_in["k_cache"],
        "A_v_cache": _A_in["v_cache"],
        "A_wq": _A_in["wq"],
        "A_wo": _A_in["wo"],
        "B_x": _B_in["x"],
        "B_k_cache": _B_in["k_cache"],
        "B_v_cache": _B_in["v_cache"],
        "B_wq": _B_in["wq"],
        "B_wo": _B_in["wo"],
    }

def reference(A_x, A_k_cache, A_v_cache, A_wq, A_wo, B_x, B_k_cache, B_v_cache, B_wq, B_wo):
    def _A_ref(x, k_cache, v_cache, wq, wo):
        B, Sq, D = x.shape
        Hq, Dh = 32, 128
        Hkv = k_cache.shape[1]
        rep = Hq // Hkv
        q = (lambda x, *d: x.permute(*d))((x @ wq).reshape(B, Sq, Hq, Dh), 0, 2, 1, 3)
        k = (lambda x, n, axis: torch.repeat_interleave(x, n, dim=axis))(k_cache, rep, axis=1)
        v = (lambda x, n, axis: torch.repeat_interleave(x, n, dim=axis))(v_cache, rep, axis=1)
        scores = torch.einsum("bhqd,bhkd->bhqk", q, k) * (Dh ** -0.5)
        p = _softmax(scores, axis=-1)
        o = torch.einsum("bhqk,bhkd->bhqd", p, v)
        return (lambda x, *d: x.permute(*d))(o, 0, 2, 1, 3).reshape(B, Sq, Hq * Dh) @ wo

    def _B_ref(x, k_cache, v_cache, wq, wo):
        B, Sq, D = x.shape
        Hq, Dh = 32, 128
        Hkv = k_cache.shape[1]
        rep = Hq // Hkv
        q = (lambda x, *d: x.permute(*d))((x @ wq).reshape(B, Sq, Hq, Dh), 0, 2, 1, 3)
        k = (lambda x, n, axis: torch.repeat_interleave(x, n, dim=axis))(k_cache, rep, axis=1)
        v = (lambda x, n, axis: torch.repeat_interleave(x, n, dim=axis))(v_cache, rep, axis=1)
        scores = torch.einsum("bhqd,bhkd->bhqk", q, k) * (Dh ** -0.5)
        p = _softmax(scores, axis=-1)
        o = torch.einsum("bhqk,bhkd->bhqd", p, v)
        return (lambda x, *d: x.permute(*d))(o, 0, 2, 1, 3).reshape(B, Sq, Hq * Dh) @ wo

    a = _A_ref(A_x, A_k_cache, A_v_cache, A_wq, A_wo)
    b = _B_ref(B_x, B_k_cache, B_v_cache, B_wq, B_wo)
    return torch.concatenate([a, b], axis=-1)
```

```asm
; @launch grid=(256,1,1) block=(768,1,1) lds=163840
.amdgcn_target "amdgcn-amd-amdhsa--gfx950"
.text
.globl concat_heads__gqa_block_cached__gqa_block_cached__near_ridge_kernel
.p2align 8
.type concat_heads__gqa_block_cached__gqa_block_cached__near_ridge_kernel,@function
concat_heads__gqa_block_cached__gqa_block_cached__near_ridge_kernel:
    s_cmp_ge_u32 s2, 256
    s_cbranch_scc1 K1_END
    s_load_dwordx16 s[32:47], s[0:1], 0
    s_load_dwordx4 s[48:51], s[0:1], 64
    s_load_dwordx2 s[52:53], s[0:1], 96
    v_lshrrev_b32 v1, 6, v0
    v_and_b32 v0, 63, v0
    v_readfirstlane_b32 s4, v1
    s_and_b32 s5, s2, 3
    s_bfe_u32 s6, s2, 0x10002
    s_lshr_b32 s7, s2, 5
    s_bfe_u32 s3, s2, 0x20003
    s_and_b32 s71, s4, 3
    s_lshr_b32 s70, s4, 2
    s_lshl_b32 s74, s5, 11
    s_lshl_b32 s73, s3, 9
    s_add_u32 s74, s74, s73
    s_mul_i32 s72, s7, 98304
    v_lshrrev_b32 v8, 5, v0
    v_and_b32 v9, 31, v0
    s_and_b32 s81, s71, 1
    s_lshl_b32 s81, s81, 1
    s_lshr_b32 s73, s71, 1
    s_lshl_b32 s73, s73, 2
    s_or_b32 s81, s81, s73
    v_or_b32 v10, s81, v8
    v_lshlrev_b32 v10, 1, v10
    v_xor_b32 v10, v9, v10
    v_lshlrev_b32 v10, 4, v10
    v_lshl_add_u32 v160, v8, 13, v10
    s_and_b32 s81, s71, 1
    s_or_b32 s81, s81, s73
    s_lshl_b32 s73, s81, 14
    v_add_u32 v160, s73, v160
    s_lshl_b32 s76, s81, 10
    s_add_u32 s79, s3, s7
    s_and_b32 s79, s79, 3
    s_lshl_b32 s79, s79, 1
    s_lshl_b32 s77, s79, 20
    s_lshl_b32 s79, s79, 8
    s_cmp_ge_u32 s4, 8
    s_cbranch_scc1 K1_LOADER
    s_add_u32 s73, s70, 1
    s_lshl_b32 s81, s73, 15
    s_add_u32 s76, s76, s81
    s_lshl_b32 s81, s73, 19
    s_add_u32 s77, s77, s81
    s_and_b32 s77, s77, 0x7fffff
    s_waitcnt lgkmcnt(0)
    s_cmp_eq_u32 s6, 0
    s_cselect_b64 s[8:9], s[32:33], s[42:43]
    s_cselect_b64 s[12:13], s[38:39], s[48:49]
    s_add_u32 s8, s8, s72
    s_addc_u32 s9, s9, 0
    s_mov_b32 s10, 98304
    s_mov_b32 s11, 0x20000
    s_add_u32 s12, s12, s74
    s_addc_u32 s13, s13, 0
    s_sub_u32 s14, 8388608, s74
    s_mov_b32 s15, 0x20000
    v_bfe_u32 v8, v0, 2, 2
    v_lshrrev_b32 v9, 4, v0
    v_and_b32 v10, 1, v9
    v_lshl_or_b32 v10, v10, 2, v8
    s_lshl_b32 s81, s4, 1
    v_xor_b32 v10, s81, v10
    v_lshl_add_u32 v11, v9, 3, v8
    v_lshlrev_b32 v11, 9, v11
    v_lshl_add_u32 v11, v10, 5, v11
    v_and_b32 v12, 3, v0
    v_lshl_add_u32 v128, v12, 3, v11
    v_xor_b32 v129, 32, v128
    v_and_b32 v8, 15, v0
    v_xor_b32 v10, v9, v8
    v_lshlrev_b32 v10, 4, v10
    v_lshl_add_u32 v10, v8, 8, v10
    v_add_u32 v130, 0x20000, v10
    v_xor_b32 v131, 64, v130
    v_xor_b32 v132, 0x80, v130
    v_xor_b32 v133, 0xc0, v130
    v_mov_b32 v64, 0
    v_mov_b32 v65, 0
    v_mov_b32 v66, 0
    v_mov_b32 v67, 0
    v_mov_b32 v68, 0
    v_mov_b32 v69, 0
    v_mov_b32 v70, 0
    v_mov_b32 v71, 0
    v_mov_b32 v72, 0
    v_mov_b32 v73, 0
    v_mov_b32 v74, 0
    v_mov_b32 v75, 0
    v_mov_b32 v76, 0
    v_mov_b32 v77, 0
    v_mov_b32 v78, 0
    v_mov_b32 v79, 0
    v_mov_b32 v80, 0
    v_mov_b32 v81, 0
    v_mov_b32 v82, 0
    v_mov_b32 v83, 0
    v_mov_b32 v84, 0
    v_mov_b32 v85, 0
    v_mov_b32 v86, 0
    v_mov_b32 v87, 0
    s_cmp_eq_u32 s6, 0
    s_cselect_b64 s[16:17], s[34:35], s[44:45]
    s_cselect_b64 s[20:21], s[36:37], s[46:47]
    s_mov_b64 s[36:37], s[40:41]
    s_lshl_b32 s73, s6, 2
    s_add_u32 s73, s73, s5
    s_lshl_b32 s73, s73, 3
    s_add_u32 s73, s73, s7
    s_lshl_b32 s73, s73, 2
    s_add_u32 s73, s73, s3
    s_mul_i32 s73, s73, 24576
    s_add_u32 s24, s52, s73
    s_addc_u32 s25, s53, 0
    s_mov_b32 s26, 24576
    s_mov_b32 s27, 0x20000
    s_lshl_b32 s73, s7, 2
    s_add_u32 s73, s73, s5
    s_lshl_b32 s73, s73, 18
    s_add_u32 s16, s16, s73
    s_addc_u32 s17, s17, 0
    s_mov_b32 s18, 262144
    s_mov_b32 s19, 0x20000
    s_add_u32 s20, s20, s73
    s_addc_u32 s21, s21, 0
    s_mov_b32 s22, 262144
    s_mov_b32 s23, 0x20000
    s_mov_b32 s42, 262144
    s_mov_b32 s43, 0x20000
    s_add_u32 s28, s52, 8388608
    s_addc_u32 s29, s53, 0
    s_mov_b32 s30, 81920
    s_lshl_b32 s45, s6, 2
    s_add_u32 s45, s45, s5
    s_lshl_b32 s45, s45, 2
    s_lshr_b32 s73, s7, 1
    s_add_u32 s45, s45, s73
    s_lshl_b32 s45, s45, 8
    s_lshl_b32 s47, s6, 2
    s_add_u32 s47, s47, s73
    s_lshl_b32 s47, s47, 3
    s_and_b32 s73, s7, 1
    s_lshl_b32 s73, s73, 2
    s_add_u32 s73, s73, s3
    s_add_u32 s47, s47, s73
    s_lshl_b32 s47, s47, 10
    s_add_u32 s47, s47, 16384
    s_mov_b32 s31, 0x20000
    s_and_b32 s82, s7, 1
    s_mul_i32 s82, s82, 98304
    s_sub_u32 s82, s8, s82
    s_subb_u32 s83, s9, 0
    s_load_dwordx2 s[96:97], s[82:83], 0
    s_mov_b32 s46, s73
    v_bfe_u32 v8, v0, 2, 2
    v_lshlrev_b32 v8, 8, v8
    v_lshrrev_b32 v9, 4, v0
    v_lshl_add_u32 v8, v9, 6, v8
    v_and_b32 v9, 3, v0
    v_lshl_add_u32 v6, v9, 4, v8
    s_lshl_b32 s73, s71, 4
    v_xor_b32 v5, s73, v6
    s_cmp_lg_u32 s4, 1
    s_cbranch_scc1 K1_NOZ
    s_lshl_b32 s81, s46, 2
    s_add_u32 s81, s81, s45
    v_mov_b32 v8, 0
    s_lshl_b32 s73, s5, 2
    s_add_u32 s73, s73, s47
    s_sub_u32 s73, s73, 128
    v_lshl_add_u32 v9, v0, 7, s73
    s_add_u32 s73, s47, 64
    s_sub_u32 s73, s73, 1152
    v_lshl_add_u32 v10, v0, 7, s73
    v_cmp_lt_u32 vcc, 8, v0
    v_cndmask_b32 v9, v9, v10, vcc
    v_writelane_b32 v9, s81, 0
    s_mov_b64 exec, 0x1ff
    buffer_store_dword v8, v9, s[28:31], 0 offen sc1
    s_mov_b64 exec, -1
K1_NOZ:
    s_mov_b32 s98, 0x3e0293ee
    s_mov_b32 s99, 0x3e0293ee
    v_and_b32 v8, 15, v0
    v_lshrrev_b32 v9, 4, v0
    s_lshl_b32 s81, s71, 2
    v_lshrrev_b32 v10, 1, v9
    v_add_u32 v10, s81, v10
    v_xor_b32 v10, v10, v8
    v_lshlrev_b32 v10, 4, v10
    v_lshl_add_u32 v10, v8, 8, v10
    v_and_b32 v11, 1, v9
    v_lshl_add_u32 v10, v11, 3, v10
    s_mul_i32 s81, s70, 12288
    s_add_u32 s81, s81, 131072
    v_add_u32 v134, s81, v10
    v_xor_b32 v135, 32, v134
    v_and_b32 v8, 31, v0
    v_lshrrev_b32 v9, 5, v0
    v_and_b32 v10, 15, v0
    v_xor_b32 v10, v9, v10
    v_lshlrev_b32 v10, 4, v10
    v_lshl_add_u32 v10, v8, 8, v10
    s_lshl_b32 s72, s70, 13
    s_add_u32 s72, s72, 131072
    v_add_u32 v7, s72, v10
    v_lshrrev_b32 v10, 2, v8
    v_and_b32 v11, 3, v10
    v_xor_b32 v11, v9, v11
    v_lshlrev_b32 v11, 4, v11
    v_lshl_add_u32 v11, v10, 10, v11
    v_and_b32 v10, 3, v0
    v_lshl_add_u32 v11, v10, 6, v11
    s_lshl_b32 s72, s71, 13
    v_add_u32 v2, s72, v11
    v_xor_b32 v3, 32, v2
    v_bfe_u32 v10, v0, 2, 2
    v_lshlrev_b32 v10, 6, v10
    v_lshl_add_u32 v10, v9, 10, v10
    v_bfe_u32 v11, v0, 4, 1
    v_lshl_add_u32 v10, v11, 5, v10
    v_bfe_u32 v11, v0, 1, 1
    v_lshl_add_u32 v10, v11, 4, v10
    v_and_b32 v11, 1, v0
    v_lshl_add_u32 v10, v11, 3, v10
    s_add_u32 s72, s72, 32768
    v_add_u32 v4, s72, v10
    s_sub_u32 s72, s70, 1
    s_lshl_b32 s72, s72, 1
    s_add_u32 s72, s72, 0
    s_add_u32 s73, s71, 0
    s_lshl_b32 s73, s73, 10
    s_lshl_b32 s74, s72, 16
    s_add_u32 s56, s74, s73
    s_lshl_b32 s74, s72, 13
    s_add_u32 s60, s74, s73
    s_sub_u32 s72, s70, 1
    s_lshl_b32 s72, s72, 1
    s_add_u32 s72, s72, 0
    s_add_u32 s73, s71, 4
    s_lshl_b32 s73, s73, 10
    s_lshl_b32 s74, s72, 16
    s_add_u32 s57, s74, s73
    s_lshl_b32 s74, s72, 13
    s_add_u32 s61, s74, s73
    s_sub_u32 s72, s70, 1
    s_lshl_b32 s72, s72, 1
    s_add_u32 s72, s72, 1
    s_add_u32 s73, s71, 0
    s_lshl_b32 s73, s73, 10
    s_lshl_b32 s74, s72, 16
    s_add_u32 s58, s74, s73
    s_lshl_b32 s74, s72, 13
    s_add_u32 s62, s74, s73
    s_sub_u32 s72, s70, 1
    s_lshl_b32 s72, s72, 1
    s_add_u32 s72, s72, 1
    s_add_u32 s73, s71, 4
    s_lshl_b32 s73, s73, 10
    s_lshl_b32 s74, s72, 16
    s_add_u32 s59, s74, s73
    s_lshl_b32 s74, s72, 13
    s_add_u32 s63, s74, s73
    s_mov_b32 s64, 0
    s_mov_b32 s66, 131072
    s_mov_b32 s65, 0
    s_mov_b32 s67, 16384
    s_mov_b32 s68, 65536
    s_mov_b32 s69, 32768
    s_mov_b32 s54, 0xff800000
    s_mov_b32 s55, 0xff800000
    s_mov_b32 s44, 0
    v_mov_b64 v[8:9], 0
    v_mov_b64 v[10:11], 0
    v_mov_b64 v[12:13], 0
    v_mov_b64 v[14:15], 0
    v_mov_b64 v[16:17], 0
    v_mov_b64 v[18:19], 0
    v_mov_b64 v[20:21], 0
    v_mov_b64 v[22:23], 0
    s_add_u32 m0, s76, 0
    s_add_u32 s72, s77, 0
    buffer_load_dwordx4 v160, s[12:15], s72 offen lds
    s_add_u32 m0, s76, 2048
    s_add_u32 s72, s77, 32768
    buffer_load_dwordx4 v160, s[12:15], s72 offen lds
    s_add_u32 m0, s76, 8192
    s_add_u32 s72, s77, 131072
    buffer_load_dwordx4 v160, s[12:15], s72 offen lds
    s_add_u32 m0, s76, 10240
    s_add_u32 s72, s77, 163840
    buffer_load_dwordx4 v160, s[12:15], s72 offen lds
    s_add_u32 m0, s76, 16384
    s_add_u32 s72, s77, 262144
    buffer_load_dwordx4 v160, s[12:15], s72 offen lds
    s_add_u32 m0, s76, 18432
    s_add_u32 s72, s77, 294912
    buffer_load_dwordx4 v160, s[12:15], s72 offen lds
    s_add_u32 m0, s76, 24576
    s_add_u32 s72, s77, 393216
    buffer_load_dwordx4 v160, s[12:15], s72 offen lds
    s_add_u32 m0, s76, 26624
    s_add_u32 s72, s77, 425984
    buffer_load_dwordx4 v160, s[12:15], s72 offen lds
    s_mov_b32 s80, 0
    s_barrier
    ds_read_b64_tr_b16 v[88:89], v128 offset:0
    ds_read_b64_tr_b16 v[90:91], v128 offset:2048
    ds_read_b64_tr_b16 v[96:97], v129 offset:0
    ds_read_b64_tr_b16 v[98:99], v129 offset:2048
    ds_read_b128 v[104:107], v130 offset:0
    ds_read_b128 v[112:115], v130 offset:4096
    ds_read_b128 v[120:123], v130 offset:8192
    ds_read_b64_tr_b16 v[92:93], v128 offset:16384
    ds_read_b64_tr_b16 v[94:95], v128 offset:18432
    ds_read_b64_tr_b16 v[100:101], v129 offset:16384
    ds_read_b64_tr_b16 v[102:103], v129 offset:18432
    ds_read_b128 v[108:111], v131 offset:0
    ds_read_b128 v[116:119], v131 offset:4096
    ds_read_b128 v[124:127], v131 offset:8192
    s_waitcnt vmcnt(0) lgkmcnt(0)
    s_branch K1_P1_MID
K1_P1_LOOP:
    s_barrier
    v_mfma_f32_16x16x32_bf16 v[64:67], v[24:27], v[40:43], v[64:67]
    ds_read_b64_tr_b16 v[88:89], v128 offset:0
    ds_read_b64_tr_b16 v[90:91], v128 offset:2048
    v_mfma_f32_16x16x32_bf16 v[76:79], v[32:35], v[40:43], v[76:79]
    ds_read_b64_tr_b16 v[96:97], v129 offset:0
    ds_read_b64_tr_b16 v[98:99], v129 offset:2048
    v_mfma_f32_16x16x32_bf16 v[68:71], v[24:27], v[48:51], v[68:71]
    ds_read_b128 v[104:107], v130 offset:0
    ds_read_b128 v[112:115], v130 offset:4096
    v_mfma_f32_16x16x32_bf16 v[80:83], v[32:35], v[48:51], v[80:83]
    ds_read_b128 v[120:123], v130 offset:8192
    ds_read_b64_tr_b16 v[92:93], v128 offset:16384
    v_mfma_f32_16x16x32_bf16 v[72:75], v[24:27], v[56:59], v[72:75]
    ds_read_b64_tr_b16 v[94:95], v128 offset:18432
    ds_read_b64_tr_b16 v[100:101], v129 offset:16384
    v_mfma_f32_16x16x32_bf16 v[84:87], v[32:35], v[56:59], v[84:87]
    ds_read_b64_tr_b16 v[102:103], v129 offset:18432
    ds_read_b128 v[108:111], v131 offset:0
    v_mfma_f32_16x16x32_bf16 v[64:67], v[28:31], v[44:47], v[64:67]
    ds_read_b128 v[116:119], v131 offset:4096
    ds_read_b128 v[124:127], v131 offset:8192
    v_mfma_f32_16x16x32_bf16 v[76:79], v[36:39], v[44:47], v[76:79]
    v_mfma_f32_16x16x32_bf16 v[68:71], v[28:31], v[52:55], v[68:71]
    v_mfma_f32_16x16x32_bf16 v[80:83], v[36:39], v[52:55], v[80:83]
    v_mfma_f32_16x16x32_bf16 v[72:75], v[28:31], v[60:63], v[72:75]
    v_mfma_f32_16x16x32_bf16 v[84:87], v[36:39], v[60:63], v[84:87]
    s_waitcnt lgkmcnt(0)
K1_P1_MID:
    s_barrier
    v_mfma_f32_16x16x32_bf16 v[64:67], v[88:91], v[104:107], v[64:67]
    ds_read_b64_tr_b16 v[24:25], v128 offset:32768
    ds_read_b64_tr_b16 v[26:27], v128 offset:34816
    v_mfma_f32_16x16x32_bf16 v[76:79], v[96:99], v[104:107], v[76:79]
    ds_read_b64_tr_b16 v[32:33], v129 offset:32768
    ds_read_b64_tr_b16 v[34:35], v129 offset:34816
    v_mfma_f32_16x16x32_bf16 v[68:71], v[88:91], v[112:115], v[68:71]
    ds_read_b128 v[40:43], v132 offset:0
    ds_read_b128 v[48:51], v132 offset:4096
    v_mfma_f32_16x16x32_bf16 v[80:83], v[96:99], v[112:115], v[80:83]
    ds_read_b128 v[56:59], v132 offset:8192
    ds_read_b64_tr_b16 v[28:29], v128 offset:49152
    v_mfma_f32_16x16x32_bf16 v[72:75], v[88:91], v[120:123], v[72:75]
    ds_read_b64_tr_b16 v[30:31], v128 offset:51200
    ds_read_b64_tr_b16 v[36:37], v129 offset:49152
    v_mfma_f32_16x16x32_bf16 v[84:87], v[96:99], v[120:123], v[84:87]
    ds_read_b64_tr_b16 v[38:39], v129 offset:51200
    ds_read_b128 v[44:47], v133 offset:0
    v_mfma_f32_16x16x32_bf16 v[64:67], v[92:95], v[108:111], v[64:67]
    ds_read_b128 v[52:55], v133 offset:4096
    ds_read_b128 v[60:63], v133 offset:8192
    v_mfma_f32_16x16x32_bf16 v[76:79], v[100:103], v[108:111], v[76:79]
    v_mfma_f32_16x16x32_bf16 v[68:71], v[92:95], v[116:119], v[68:71]
    v_mfma_f32_16x16x32_bf16 v[80:83], v[100:103], v[116:119], v[80:83]
    v_mfma_f32_16x16x32_bf16 v[72:75], v[92:95], v[124:127], v[72:75]
    v_mfma_f32_16x16x32_bf16 v[84:87], v[100:103], v[124:127], v[84:87]
    v_xor_b32 v128, 0x10000, v128
    v_xor_b32 v129, 0x10000, v129
    v_xor_b32 v130, 0x4000, v130
    v_xor_b32 v131, 0x4000, v131
    v_xor_b32 v132, 0x4000, v132
    v_xor_b32 v133, 0x4000, v133
    s_add_u32 s80, s80, 1
    s_waitcnt lgkmcnt(0)
    s_cmp_lt_u32 s80, 8
    s_cbranch_scc1 K1_P1_LOOP
    s_barrier
    ds_read_b128 v[136:139], v2 offset:0
    ds_read_b128 v[140:143], v3 offset:0
    ds_read_b128 v[144:147], v2 offset:256
    ds_read_b128 v[148:151], v3 offset:256
    ds_read_b128 v[152:155], v2 offset:512
    ds_read_b128 v[156:159], v3 offset:512
    ds_read_b128 v[160:163], v2 offset:768
    ds_read_b128 v[164:167], v3 offset:768
    v_mfma_f32_16x16x32_bf16 v[64:67], v[24:27], v[40:43], v[64:67]
    v_mfma_f32_16x16x32_bf16 v[76:79], v[32:35], v[40:43], v[76:79]
    v_mfma_f32_16x16x32_bf16 v[68:71], v[24:27], v[48:51], v[68:71]
    v_mfma_f32_16x16x32_bf16 v[80:83], v[32:35], v[48:51], v[80:83]
    v_mfma_f32_16x16x32_bf16 v[72:75], v[24:27], v[56:59], v[72:75]
    v_mfma_f32_16x16x32_bf16 v[84:87], v[32:35], v[56:59], v[84:87]
    v_mfma_f32_16x16x32_bf16 v[64:67], v[28:31], v[44:47], v[64:67]
    v_mfma_f32_16x16x32_bf16 v[76:79], v[36:39], v[44:47], v[76:79]
    v_mfma_f32_16x16x32_bf16 v[68:71], v[28:31], v[52:55], v[68:71]
    v_mfma_f32_16x16x32_bf16 v[80:83], v[36:39], v[52:55], v[80:83]
    v_mfma_f32_16x16x32_bf16 v[72:75], v[28:31], v[60:63], v[72:75]
    v_mfma_f32_16x16x32_bf16 v[84:87], v[36:39], v[60:63], v[84:87]
    s_nop 7
    v_pk_mul_f32 v[64:65], v[64:65], s[98:99]
    v_pk_mul_f32 v[66:67], v[66:67], s[98:99]
    v_cvt_pk_bf16_f32 v64, v64, v65
    v_cvt_pk_bf16_f32 v65, v66, v67
    ds_write_b64 v134, v[64:65] offset:0
    v_pk_mul_f32 v[68:69], v[68:69], s[98:99]
    v_pk_mul_f32 v[70:71], v[70:71], s[98:99]
    v_cvt_pk_bf16_f32 v68, v68, v69
    v_cvt_pk_bf16_f32 v69, v70, v71
    ds_write_b64 v134, v[68:69] offset:4096
    v_pk_mul_f32 v[72:73], v[72:73], s[98:99]
    v_pk_mul_f32 v[74:75], v[74:75], s[98:99]
    v_cvt_pk_bf16_f32 v72, v72, v73
    v_cvt_pk_bf16_f32 v73, v74, v75
    ds_write_b64 v134, v[72:73] offset:8192
    v_pk_mul_f32 v[76:77], v[76:77], s[98:99]
    v_pk_mul_f32 v[78:79], v[78:79], s[98:99]
    v_cvt_pk_bf16_f32 v76, v76, v77
    v_cvt_pk_bf16_f32 v77, v78, v79
    ds_write_b64 v135, v[76:77] offset:0
    v_pk_mul_f32 v[80:81], v[80:81], s[98:99]
    v_pk_mul_f32 v[82:83], v[82:83], s[98:99]
    v_cvt_pk_bf16_f32 v80, v80, v81
    v_cvt_pk_bf16_f32 v81, v82, v83
    ds_write_b64 v135, v[80:81] offset:4096
    v_pk_mul_f32 v[84:85], v[84:85], s[98:99]
    v_pk_mul_f32 v[86:87], v[86:87], s[98:99]
    v_cvt_pk_bf16_f32 v84, v84, v85
    v_cvt_pk_bf16_f32 v85, v86, v87
    ds_write_b64 v135, v[84:85] offset:8192
    s_waitcnt lgkmcnt(0)
    s_branch K1_JOIN
K1_LOADER:
    s_setprio 3
    s_sub_u32 s75, s4, 8
    v_lshrrev_b32 v8, 4, v0
    v_and_b32 v9, 15, v0
    s_lshl_b32 s81, s75, 2
    v_or_b32 v10, s81, v8
    v_xor_b32 v11, v9, v10
    v_lshlrev_b32 v11, 4, v11
    v_lshl_add_u32 v153, v10, 11, v11
    s_lshl_b32 s78, s75, 10
    s_add_u32 s78, s78, 131072
    s_waitcnt lgkmcnt(0)
    s_cmp_eq_u32 s6, 0
    s_cselect_b64 s[8:9], s[32:33], s[42:43]
    s_cselect_b64 s[12:13], s[38:39], s[48:49]
    s_add_u32 s8, s8, s72
    s_addc_u32 s9, s9, 0
    s_mov_b32 s10, 98304
    s_mov_b32 s11, 0x20000
    s_add_u32 s12, s12, s74
    s_addc_u32 s13, s13, 0
    s_sub_u32 s14, 8388608, s74
    s_mov_b32 s15, 0x20000
    s_add_u32 m0, s78, 0
    s_add_u32 s72, s79, 0
    buffer_load_dwordx4 v153, s[8:11], s72 offen lds
    s_add_u32 m0, s78, 4096
    s_add_u32 s72, s79, 32768
    buffer_load_dwordx4 v153, s[8:11], s72 offen lds
    s_add_u32 m0, s78, 8192
    s_add_u32 s72, s79, 65536
    buffer_load_dwordx4 v153, s[8:11], s72 offen lds
    s_add_u32 m0, s76, 0
    s_add_u32 s72, s77, 0
    buffer_load_dwordx4 v160, s[12:15], s72 offen lds
    s_add_u32 m0, s76, 2048
    s_add_u32 s72, s77, 32768
    buffer_load_dwordx4 v160, s[12:15], s72 offen lds
    s_add_u32 m0, s76, 8192
    s_add_u32 s72, s77, 131072
    buffer_load_dwordx4 v160, s[12:15], s72 offen lds
    s_add_u32 m0, s76, 10240
    s_add_u32 s72, s77, 163840
    buffer_load_dwordx4 v160, s[12:15], s72 offen lds
    s_add_u32 m0, s76, 16384
    s_add_u32 s72, s77, 262144
    buffer_load_dwordx4 v160, s[12:15], s72 offen lds
    s_add_u32 m0, s76, 18432
    s_add_u32 s72, s77, 294912
    buffer_load_dwordx4 v160, s[12:15], s72 offen lds
    s_add_u32 m0, s76, 24576
    s_add_u32 s72, s77, 393216
    buffer_load_dwordx4 v160, s[12:15], s72 offen lds
    s_add_u32 m0, s76, 26624
    s_add_u32 s72, s77, 425984
    buffer_load_dwordx4 v160, s[12:15], s72 offen lds
    s_add_u32 s76, s76, 98304
    s_add_u32 s77, s77, 1572864
    s_and_b32 s77, s77, 0x7fffff
    s_cmp_eq_u32 s6, 0
    s_cselect_b64 s[16:17], s[34:35], s[44:45]
    s_cselect_b64 s[20:21], s[36:37], s[46:47]
    s_mov_b64 s[36:37], s[40:41]
    s_lshl_b32 s73, s6, 2
    s_add_u32 s73, s73, s5
    s_lshl_b32 s73, s73, 3
    s_add_u32 s73, s73, s7
    s_lshl_b32 s73, s73, 2
    s_add_u32 s73, s73, s3
    s_mul_i32 s73, s73, 24576
    s_add_u32 s24, s52, s73
    s_addc_u32 s25, s53, 0
    s_mov_b32 s26, 24576
    s_mov_b32 s27, 0x20000
    s_lshl_b32 s73, s7, 2
    s_add_u32 s73, s73, s5
    s_lshl_b32 s73, s73, 18
    s_add_u32 s16, s16, s73
    s_addc_u32 s17, s17, 0
    s_mov_b32 s18, 262144
    s_mov_b32 s19, 0x20000
    s_add_u32 s20, s20, s73
    s_addc_u32 s21, s21, 0
    s_mov_b32 s22, 262144
    s_mov_b32 s23, 0x20000
    s_mov_b32 s42, 262144
    s_mov_b32 s43, 0x20000
    s_add_u32 s28, s52, 8388608
    s_addc_u32 s29, s53, 0
    s_mov_b32 s30, 81920
    s_lshl_b32 s45, s6, 2
    s_add_u32 s45, s45, s5
    s_lshl_b32 s45, s45, 2
    s_lshr_b32 s73, s7, 1
    s_add_u32 s45, s45, s73
    s_lshl_b32 s45, s45, 8
    s_lshl_b32 s47, s6, 2
    s_add_u32 s47, s47, s73
    s_lshl_b32 s47, s47, 3
    s_and_b32 s73, s7, 1
    s_lshl_b32 s73, s73, 2
    s_add_u32 s73, s73, s3
    s_add_u32 s47, s47, s73
    s_lshl_b32 s47, s47, 10
    s_add_u32 s47, s47, 16384
    s_mov_b32 s31, 0x20000
    s_and_b32 s82, s7, 1
    s_mul_i32 s82, s82, 98304
    s_sub_u32 s82, s8, s82
    s_subb_u32 s83, s9, 0
    s_load_dwordx2 s[96:97], s[82:83], 0
    s_mov_b32 s46, s73
    v_bfe_u32 v8, v0, 2, 2
    v_lshlrev_b32 v8, 8, v8
    v_lshrrev_b32 v9, 4, v0
    v_lshl_add_u32 v8, v9, 6, v8
    v_and_b32 v9, 3, v0
    v_lshl_add_u32 v6, v9, 4, v8
    s_lshl_b32 s73, s71, 4
    v_xor_b32 v5, s73, v6
    v_and_b32 v8, 31, v0
    v_lshrrev_b32 v9, 5, v0
    v_and_b32 v10, 15, v0
    v_xor_b32 v10, v9, v10
    v_lshlrev_b32 v10, 4, v10
    v_lshl_add_u32 v10, v8, 8, v10
    s_lshl_b32 s72, s70, 13
    s_add_u32 s72, s72, 131072
    v_add_u32 v7, s72, v10
    v_lshrrev_b32 v10, 2, v8
    v_and_b32 v11, 3, v10
    v_xor_b32 v11, v9, v11
    v_lshlrev_b32 v11, 4, v11
    v_lshl_add_u32 v11, v10, 10, v11
    v_and_b32 v10, 3, v0
    v_lshl_add_u32 v11, v10, 6, v11
    s_lshl_b32 s72, s71, 13
    v_add_u32 v2, s72, v11
    v_xor_b32 v3, 32, v2
    v_bfe_u32 v10, v0, 2, 2
    v_lshlrev_b32 v10, 6, v10
    v_lshl_add_u32 v10, v9, 10, v10
    v_bfe_u32 v11, v0, 4, 1
    v_lshl_add_u32 v10, v11, 5, v10
    v_bfe_u32 v11, v0, 1, 1
    v_lshl_add_u32 v10, v11, 4, v10
    v_and_b32 v11, 1, v0
    v_lshl_add_u32 v10, v11, 3, v10
    s_add_u32 s72, s72, 32768
    v_add_u32 v4, s72, v10
    s_sub_u32 s72, s70, 1
    s_lshl_b32 s72, s72, 1
    s_add_u32 s72, s72, 0
    s_add_u32 s73, s71, 0
    s_lshl_b32 s73, s73, 10
    s_lshl_b32 s74, s72, 16
    s_add_u32 s56, s74, s73
    s_lshl_b32 s74, s72, 13
    s_add_u32 s60, s74, s73
    s_sub_u32 s72, s70, 1
    s_lshl_b32 s72, s72, 1
    s_add_u32 s72, s72, 0
    s_add_u32 s73, s71, 4
    s_lshl_b32 s73, s73, 10
    s_lshl_b32 s74, s72, 16
    s_add_u32 s57, s74, s73
    s_lshl_b32 s74, s72, 13
    s_add_u32 s61, s74, s73
    s_sub_u32 s72, s70, 1
    s_lshl_b32 s72, s72, 1
    s_add_u32 s72, s72, 1
    s_add_u32 s73, s71, 0
    s_lshl_b32 s73, s73, 10
    s_lshl_b32 s74, s72, 16
    s_add_u32 s58, s74, s73
    s_lshl_b32 s74, s72, 13
    s_add_u32 s62, s74, s73
    s_sub_u32 s72, s70, 1
    s_lshl_b32 s72, s72, 1
    s_add_u32 s72, s72, 1
    s_add_u32 s73, s71, 4
    s_lshl_b32 s73, s73, 10
    s_lshl_b32 s74, s72, 16
    s_add_u32 s59, s74, s73
    s_lshl_b32 s74, s72, 13
    s_add_u32 s63, s74, s73
    s_mov_b32 s64, 0
    s_mov_b32 s66, 131072
    s_mov_b32 s65, 0
    s_mov_b32 s67, 16384
    s_mov_b32 s68, 65536
    s_mov_b32 s69, 32768
    s_mov_b32 s54, 0xff800000
    s_mov_b32 s55, 0xff800000
    s_mov_b32 s44, 0
    v_mov_b64 v[8:9], 0
    v_mov_b64 v[10:11], 0
    v_mov_b64 v[12:13], 0
    v_mov_b64 v[14:15], 0
    v_mov_b64 v[16:17], 0
    v_mov_b64 v[18:19], 0
    v_mov_b64 v[20:21], 0
    v_mov_b64 v[22:23], 0
    s_mov_b32 s80, 0
    s_waitcnt vmcnt(0)
    s_setprio 0
    s_barrier
    s_branch K1_LD_MID
K1_LD_LOOP:
    s_waitcnt vmcnt(16)
    s_barrier
K1_LD_MID:
    s_xor_b32 s78, s78, 0x4000
    s_add_u32 s79, s79, 256
    s_and_b32 s79, s79, 0x7ff
    s_add_u32 m0, s78, 0
    s_add_u32 s72, s79, 0
    buffer_load_dwordx4 v153, s[8:11], s72 offen lds
    s_add_u32 m0, s78, 4096
    s_add_u32 s72, s79, 32768
    buffer_load_dwordx4 v153, s[8:11], s72 offen lds
    s_add_u32 m0, s78, 8192
    s_add_u32 s72, s79, 65536
    buffer_load_dwordx4 v153, s[8:11], s72 offen lds
    s_add_u32 m0, s76, 0
    s_add_u32 s72, s77, 0
    buffer_load_dwordx4 v160, s[12:15], s72 offen lds
    s_add_u32 m0, s76, 2048
    s_add_u32 s72, s77, 32768
    buffer_load_dwordx4 v160, s[12:15], s72 offen lds
    s_add_u32 m0, s76, 8192
    s_add_u32 s72, s77, 131072
    buffer_load_dwordx4 v160, s[12:15], s72 offen lds
    s_add_u32 m0, s76, 10240
    s_add_u32 s72, s77, 163840
    buffer_load_dwordx4 v160, s[12:15], s72 offen lds
    s_add_u32 m0, s76, 16384
    s_add_u32 s72, s77, 262144
    buffer_load_dwordx4 v160, s[12:15], s72 offen lds
    s_add_u32 m0, s76, 18432
    s_add_u32 s72, s77, 294912
    buffer_load_dwordx4 v160, s[12:15], s72 offen lds
    s_add_u32 m0, s76, 24576
    s_add_u32 s72, s77, 393216
    buffer_load_dwordx4 v160, s[12:15], s72 offen lds
    s_add_u32 m0, s76, 26624
    s_add_u32 s72, s77, 425984
    buffer_load_dwordx4 v160, s[12:15], s72 offen lds
    s_add_u32 s76, s76, 32768
    s_and_b32 s76, s76, 0x1ffff
    s_add_u32 s77, s77, 524288
    s_and_b32 s77, s77, 0x7fffff
K1_LD_MID2:
    s_waitcnt vmcnt(19)
    s_barrier
    s_add_u32 m0, s76, 0
    s_add_u32 s72, s77, 0
    buffer_load_dwordx4 v160, s[12:15], s72 offen lds
    s_add_u32 m0, s76, 2048
    s_add_u32 s72, s77, 32768
    buffer_load_dwordx4 v160, s[12:15], s72 offen lds
    s_add_u32 m0, s76, 8192
    s_add_u32 s72, s77, 131072
    buffer_load_dwordx4 v160, s[12:15], s72 offen lds
    s_add_u32 m0, s76, 10240
    s_add_u32 s72, s77, 163840
    buffer_load_dwordx4 v160, s[12:15], s72 offen lds
    s_add_u32 m0, s76, 16384
    s_add_u32 s72, s77, 262144
    buffer_load_dwordx4 v160, s[12:15], s72 offen lds
    s_add_u32 m0, s76, 18432
    s_add_u32 s72, s77, 294912
    buffer_load_dwordx4 v160, s[12:15], s72 offen lds
    s_add_u32 m0, s76, 24576
    s_add_u32 s72, s77, 393216
    buffer_load_dwordx4 v160, s[12:15], s72 offen lds
    s_add_u32 m0, s76, 26624
    s_add_u32 s72, s77, 425984
    buffer_load_dwordx4 v160, s[12:15], s72 offen lds
    s_add_u32 s76, s76, 32768
    s_and_b32 s76, s76, 0x1ffff
    s_add_u32 s77, s77, 524288
    s_and_b32 s77, s77, 0x7fffff
    s_add_u32 s80, s80, 1
    s_cmp_lt_u32 s80, 6
    s_cbranch_scc1 K1_LD_LOOP
    s_waitcnt vmcnt(16)
    s_barrier
    s_xor_b32 s78, s78, 0x4000
    s_add_u32 s79, s79, 256
    s_and_b32 s79, s79, 0x7ff
    s_add_u32 m0, s78, 0
    s_add_u32 s72, s79, 0
    buffer_load_dwordx4 v153, s[8:11], s72 offen lds
    s_add_u32 m0, s78, 4096
    s_add_u32 s72, s79, 32768
    buffer_load_dwordx4 v153, s[8:11], s72 offen lds
    s_add_u32 m0, s78, 8192
    s_add_u32 s72, s79, 65536
    buffer_load_dwordx4 v153, s[8:11], s72 offen lds
    s_add_u32 m0, s76, 0
    s_add_u32 s72, s77, 0
    buffer_load_dwordx4 v160, s[12:15], s72 offen lds
    s_add_u32 m0, s76, 2048
    s_add_u32 s72, s77, 32768
    buffer_load_dwordx4 v160, s[12:15], s72 offen lds
    s_add_u32 m0, s76, 8192
    s_add_u32 s72, s77, 131072
    buffer_load_dwordx4 v160, s[12:15], s72 offen lds
    s_add_u32 m0, s76, 10240
    s_add_u32 s72, s77, 163840
    buffer_load_dwordx4 v160, s[12:15], s72 offen lds
    s_add_u32 m0, s76, 16384
    s_add_u32 s72, s77, 262144
    buffer_load_dwordx4 v160, s[12:15], s72 offen lds
    s_add_u32 m0, s76, 18432
    s_add_u32 s72, s77, 294912
    buffer_load_dwordx4 v160, s[12:15], s72 offen lds
    s_add_u32 m0, s76, 24576
    s_add_u32 s72, s77, 393216
    buffer_load_dwordx4 v160, s[12:15], s72 offen lds
    s_add_u32 m0, s76, 26624
    s_add_u32 s72, s77, 425984
    buffer_load_dwordx4 v160, s[12:15], s72 offen lds
    s_waitcnt vmcnt(19)
    s_barrier
    s_lshl_b32 s73, s75, 10
    s_add_u32 m0, s73, 0
    s_add_u32 s72, s73, 0
    buffer_load_dwordx4 v5, s[16:19], s72 offen lds
    s_add_u32 m0, s73, 4096
    s_add_u32 s72, s73, 4096
    buffer_load_dwordx4 v5, s[16:19], s72 offen lds
    s_add_u32 m0, s73, 8192
    s_add_u32 s72, s73, 65536
    buffer_load_dwordx4 v5, s[16:19], s72 offen lds
    s_add_u32 m0, s73, 12288
    s_add_u32 s72, s73, 69632
    buffer_load_dwordx4 v5, s[16:19], s72 offen lds
    s_add_u32 m0, s73, 16384
    s_add_u32 s72, s73, 131072
    buffer_load_dwordx4 v5, s[16:19], s72 offen lds
    s_add_u32 m0, s73, 20480
    s_add_u32 s72, s73, 135168
    buffer_load_dwordx4 v5, s[16:19], s72 offen lds
    s_add_u32 m0, s73, 24576
    s_add_u32 s72, s73, 196608
    buffer_load_dwordx4 v5, s[16:19], s72 offen lds
    s_add_u32 m0, s73, 28672
    s_add_u32 s72, s73, 200704
    buffer_load_dwordx4 v5, s[16:19], s72 offen lds
    s_waitcnt vmcnt(16)
    s_barrier
    s_lshl_b32 s73, s75, 10
    s_add_u32 m0, s73, 32768
    s_add_u32 s72, s73, 0
    buffer_load_dwordx4 v6, s[20:23], s72 offen lds
    s_add_u32 m0, s73, 36864
    s_add_u32 s72, s73, 4096
    buffer_load_dwordx4 v6, s[20:23], s72 offen lds
    s_add_u32 m0, s73, 40960
    s_add_u32 s72, s73, 65536
    buffer_load_dwordx4 v6, s[20:23], s72 offen lds
    s_add_u32 m0, s73, 45056
    s_add_u32 s72, s73, 69632
    buffer_load_dwordx4 v6, s[20:23], s72 offen lds
    s_add_u32 m0, s73, 49152
    s_add_u32 s72, s73, 131072
    buffer_load_dwordx4 v6, s[20:23], s72 offen lds
    s_add_u32 m0, s73, 53248
    s_add_u32 s72, s73, 135168
    buffer_load_dwordx4 v6, s[20:23], s72 offen lds
    s_add_u32 m0, s73, 57344
    s_add_u32 s72, s73, 196608
    buffer_load_dwordx4 v6, s[20:23], s72 offen lds
    s_add_u32 m0, s73, 61440
    s_add_u32 s72, s73, 200704
    buffer_load_dwordx4 v6, s[20:23], s72 offen lds
    s_waitcnt vmcnt(16)
    s_barrier
    s_lshl_b32 s73, s75, 10
    s_add_u32 m0, s73, 65536
    s_add_u32 s72, s73, 8192
    buffer_load_dwordx4 v5, s[16:19], s72 offen lds
    s_add_u32 m0, s73, 69632
    s_add_u32 s72, s73, 12288
    buffer_load_dwordx4 v5, s[16:19], s72 offen lds
    s_add_u32 m0, s73, 73728
    s_add_u32 s72, s73, 73728
    buffer_load_dwordx4 v5, s[16:19], s72 offen lds
    s_add_u32 m0, s73, 77824
    s_add_u32 s72, s73, 77824
    buffer_load_dwordx4 v5, s[16:19], s72 offen lds
    s_add_u32 m0, s73, 81920
    s_add_u32 s72, s73, 139264
    buffer_load_dwordx4 v5, s[16:19], s72 offen lds
    s_add_u32 m0, s73, 86016
    s_add_u32 s72, s73, 143360
    buffer_load_dwordx4 v5, s[16:19], s72 offen lds
    s_add_u32 m0, s73, 90112
    s_add_u32 s72, s73, 204800
    buffer_load_dwordx4 v5, s[16:19], s72 offen lds
    s_add_u32 m0, s73, 94208
    s_add_u32 s72, s73, 208896
    buffer_load_dwordx4 v5, s[16:19], s72 offen lds
    s_waitcnt vmcnt(16)
    s_barrier
    s_lshl_b32 s73, s75, 10
    s_add_u32 m0, s73, 98304
    s_add_u32 s72, s73, 8192
    buffer_load_dwordx4 v6, s[20:23], s72 offen lds
    s_add_u32 m0, s73, 102400
    s_add_u32 s72, s73, 12288
    buffer_load_dwordx4 v6, s[20:23], s72 offen lds
    s_add_u32 m0, s73, 106496
    s_add_u32 s72, s73, 73728
    buffer_load_dwordx4 v6, s[20:23], s72 offen lds
    s_add_u32 m0, s73, 110592
    s_add_u32 s72, s73, 77824
    buffer_load_dwordx4 v6, s[20:23], s72 offen lds
    s_add_u32 m0, s73, 114688
    s_add_u32 s72, s73, 139264
    buffer_load_dwordx4 v6, s[20:23], s72 offen lds
    s_add_u32 m0, s73, 118784
    s_add_u32 s72, s73, 143360
    buffer_load_dwordx4 v6, s[20:23], s72 offen lds
    s_add_u32 m0, s73, 122880
    s_add_u32 s72, s73, 204800
    buffer_load_dwordx4 v6, s[20:23], s72 offen lds
    s_add_u32 m0, s73, 126976
    s_add_u32 s72, s73, 208896
    buffer_load_dwordx4 v6, s[20:23], s72 offen lds
    ds_read_b128 v[136:139], v2 offset:0
    ds_read_b128 v[140:143], v3 offset:0
    ds_read_b128 v[144:147], v2 offset:256
    ds_read_b128 v[148:151], v3 offset:256
    ds_read_b128 v[152:155], v2 offset:512
    ds_read_b128 v[156:159], v3 offset:512
    ds_read_b128 v[160:163], v2 offset:768
    ds_read_b128 v[164:167], v3 offset:768
K1_JOIN:
    s_waitcnt lgkmcnt(0)
    s_lshl_b32 s72, s97, 7
    s_xor_b32 s96, s96, s72
    s_or_b32 s96, s96, 1
    s_barrier
    v_xor_b32 v0, 0x0, v7
    ds_read_b128 v[88:91], v0
    v_xor_b32 v0, 0x20, v7
    ds_read_b128 v[92:95], v0
    v_xor_b32 v0, 0x40, v7
    ds_read_b128 v[96:99], v0
    v_xor_b32 v0, 0x60, v7
    ds_read_b128 v[100:103], v0
    v_xor_b32 v0, 0x80, v7
    ds_read_b128 v[104:107], v0
    v_xor_b32 v0, 0xa0, v7
    ds_read_b128 v[108:111], v0
    v_xor_b32 v0, 0xc0, v7
    ds_read_b128 v[112:115], v0
    v_xor_b32 v0, 0xe0, v7
    ds_read_b128 v[116:119], v0
K1_JOIN2:
    v_mov_b64 v[24:25], 0
    v_mov_b64 v[26:27], 0
    v_mov_b64 v[28:29], 0
    v_mov_b64 v[30:31], 0
    v_mov_b64 v[32:33], 0
    v_mov_b64 v[34:35], 0
    v_mov_b64 v[36:37], 0
    v_mov_b64 v[38:39], 0
    v_mov_b64 v[40:41], 0
    v_mov_b64 v[42:43], 0
    v_mov_b64 v[44:45], 0
    v_mov_b64 v[46:47], 0
    v_mov_b64 v[48:49], 0
    v_mov_b64 v[50:51], 0
    v_mov_b64 v[52:53], 0
    v_mov_b64 v[54:55], 0
    v_mov_b64 v[56:57], 0
    v_mov_b64 v[58:59], 0
    v_mov_b64 v[60:61], 0
    v_mov_b64 v[62:63], 0
    v_mov_b64 v[64:65], 0
    v_mov_b64 v[66:67], 0
    v_mov_b64 v[68:69], 0
    v_mov_b64 v[70:71], 0
    v_mov_b64 v[72:73], 0
    v_mov_b64 v[74:75], 0
    v_mov_b64 v[76:77], 0
    v_mov_b64 v[78:79], 0
    v_mov_b64 v[80:81], 0
    v_mov_b64 v[82:83], 0
    v_mov_b64 v[84:85], 0
    v_mov_b64 v[86:87], 0
    v_mov_b32 v1, 0
    s_mov_b32 s76, 65536
    s_cmp_eq_u32 s70, 0
    s_cselect_b32 s78, 99, 99
    s_waitcnt lgkmcnt(0)
    s_cmp_lt_u32 s4, 4
    s_cbranch_scc1 K1_A_BAR
    s_waitcnt vmcnt(8)
    s_branch K1_B_BAR
K1_B_TOP:
    s_waitcnt vmcnt(4) lgkmcnt(0)
K1_B_BAR:
    s_setprio 2
    s_barrier
    s_add_u32 m0, s66, s60
    s_add_u32 s72, s67, s56
    buffer_load_dwordx4 v5, s[16:19], s72 offen lds
    s_add_u32 m0, s66, s61
    s_add_u32 s72, s67, s57
    buffer_load_dwordx4 v5, s[16:19], s72 offen lds
    s_add_u32 m0, s66, s62
    s_add_u32 s72, s67, s58
    buffer_load_dwordx4 v5, s[16:19], s72 offen lds
    s_add_u32 m0, s66, s63
    s_add_u32 s72, s67, s59
    buffer_load_dwordx4 v5, s[16:19], s72 offen lds
    v_mfma_f32_32x32x16_bf16 v[120:135], v[136:139], v[88:91], v[8:23]
    ds_read_b64_tr_b16 v[136:137], v4 offset:0
    ds_read_b64_tr_b16 v[138:139], v4 offset:2048
    v_add_u32 v2, s76, v2
    v_add_u32 v3, s76, v3
    s_mov_b32 s76, s68
    v_mfma_f32_32x32x16_bf16 v[120:135], v[140:143], v[92:95], v[120:135]
    ds_read_b64_tr_b16 v[140:141], v4 offset:256
    ds_read_b64_tr_b16 v[142:143], v4 offset:2304
    v_mfma_f32_32x32x16_bf16 v[120:135], v[144:147], v[96:99], v[120:135]
    ds_read_b64_tr_b16 v[144:145], v4 offset:512
    ds_read_b64_tr_b16 v[146:147], v4 offset:2560
    s_add_u32 s68, s68, 65536
    s_cmp_ge_u32 s68, 163840
    s_cselect_b32 s72, 163840, 0
    s_sub_u32 s68, s68, s72
    v_mfma_f32_32x32x16_bf16 v[120:135], v[148:151], v[100:103], v[120:135]
    ds_read_b64_tr_b16 v[148:149], v4 offset:768
    ds_read_b64_tr_b16 v[150:151], v4 offset:2816
    v_mfma_f32_32x32x16_bf16 v[120:135], v[152:155], v[104:107], v[120:135]
    ds_read_b64_tr_b16 v[152:153], v4 offset:4096
    ds_read_b64_tr_b16 v[154:155], v4 offset:6144
    s_sub_u32 s76, s68, s76
    s_mov_b32 s77, s69
    s_add_u32 s69, s69, 65536
    s_cmp_ge_u32 s69, 163840
    s_cselect_b32 s72, 163840, 0
    s_sub_u32 s69, s69, s72
    v_mfma_f32_32x32x16_bf16 v[120:135], v[156:159], v[108:111], v[120:135]
    ds_read_b64_tr_b16 v[156:157], v4 offset:4352
    ds_read_b64_tr_b16 v[158:159], v4 offset:6400
    v_mfma_f32_32x32x16_bf16 v[120:135], v[160:163], v[112:115], v[120:135]
    ds_read_b64_tr_b16 v[160:161], v4 offset:4608
    ds_read_b64_tr_b16 v[162:163], v4 offset:6656
    v_mfma_f32_32x32x16_bf16 v[120:135], v[164:167], v[116:119], v[120:135]
    s_setprio 1
    ds_read_b64_tr_b16 v[164:165], v4 offset:4864
    ds_read_b64_tr_b16 v[166:167], v4 offset:6912
    s_sub_u32 s77, s69, s77
    v_add_u32 v4, s77, v4
    s_nop 6
    s_cmp_lt_u32 s64, s44
    s_cbranch_scc1 K1_B_MAX
K1_B_CONT:
    v_exp_f32 v120, v120
    v_exp_f32 v121, v121
    v_exp_f32 v122, v122
    v_exp_f32 v123, v123
    v_add_f32 v1, v1, v120
    v_add_f32 v1, v1, v121
    v_cvt_pk_bf16_f32 v120, v120, v121
    v_exp_f32 v124, v124
    v_exp_f32 v125, v125
    v_add_f32 v1, v1, v122
    v_add_f32 v1, v1, v123
    v_cvt_pk_bf16_f32 v121, v122, v123
    v_exp_f32 v126, v126
    v_exp_f32 v127, v127
    v_add_f32 v1, v1, v124
    v_add_f32 v1, v1, v125
    v_cvt_pk_bf16_f32 v122, v124, v125
    v_exp_f32 v128, v128
    v_exp_f32 v129, v129
    v_add_f32 v1, v1, v126
    v_add_f32 v1, v1, v127
    v_cvt_pk_bf16_f32 v123, v126, v127
    v_exp_f32 v130, v130
    v_exp_f32 v131, v131
    v_add_f32 v1, v1, v128
    v_add_f32 v1, v1, v129
    v_cvt_pk_bf16_f32 v124, v128, v129
    v_exp_f32 v132, v132
    v_exp_f32 v133, v133
    v_add_f32 v1, v1, v130
    v_add_f32 v1, v1, v131
    v_cvt_pk_bf16_f32 v125, v130, v131
    v_exp_f32 v134, v134
    v_exp_f32 v135, v135
    v_add_f32 v1, v1, v132
    v_add_f32 v1, v1, v133
    v_cvt_pk_bf16_f32 v126, v132, v133
    v_add_f32 v1, v1, v134
    v_add_f32 v1, v1, v135
    v_cvt_pk_bf16_f32 v127, v134, v135
    s_setprio 0
    s_waitcnt lgkmcnt(0)
    v_mfma_f32_32x32x16_bf16 v[24:39], v[136:139], v[120:123], v[24:39]
    ds_read_b128 v[136:139], v2 offset:0
    s_add_u32 m0, s65, s60
    s_add_u32 s72, s67, s56
    buffer_load_dwordx4 v6, s[20:23], s72 offen lds
    v_mfma_f32_32x32x16_bf16 v[40:55], v[140:143], v[120:123], v[40:55]
    ds_read_b128 v[140:143], v3 offset:0
    s_add_u32 m0, s65, s61
    s_add_u32 s72, s67, s57
    buffer_load_dwordx4 v6, s[20:23], s72 offen lds
    v_mfma_f32_32x32x16_bf16 v[56:71], v[144:147], v[120:123], v[56:71]
    ds_read_b128 v[144:147], v2 offset:256
    s_add_u32 m0, s65, s62
    s_add_u32 s72, s67, s58
    buffer_load_dwordx4 v6, s[20:23], s72 offen lds
    v_mfma_f32_32x32x16_bf16 v[72:87], v[148:151], v[120:123], v[72:87]
    ds_read_b128 v[148:151], v3 offset:256
    s_add_u32 m0, s65, s63
    s_add_u32 s72, s67, s59
    buffer_load_dwordx4 v6, s[20:23], s72 offen lds
    v_mfma_f32_32x32x16_bf16 v[24:39], v[152:155], v[124:127], v[24:39]
    ds_read_b128 v[152:155], v2 offset:512
    s_add_u32 s64, s64, 1
    s_add_u32 s65, s65, 65536
    s_cmp_ge_u32 s65, 163840
    s_cselect_b32 s72, 163840, 0
    s_sub_u32 s65, s65, s72
    v_mfma_f32_32x32x16_bf16 v[40:55], v[156:159], v[124:127], v[40:55]
    ds_read_b128 v[156:159], v3 offset:512
    s_add_u32 s66, s66, 65536
    s_cmp_ge_u32 s66, 163840
    s_cselect_b32 s72, 163840, 0
    s_sub_u32 s66, s66, s72
    v_mfma_f32_32x32x16_bf16 v[56:71], v[160:163], v[124:127], v[56:71]
    ds_read_b128 v[160:163], v2 offset:768
    s_add_u32 s67, s67, 8192
    v_mfma_f32_32x32x16_bf16 v[72:87], v[164:167], v[124:127], v[72:87]
    ds_read_b128 v[164:167], v3 offset:768
    s_cmp_lt_u32 s64, 6
    s_cbranch_scc1 K1_B_TOP
    s_waitcnt vmcnt(4)
    s_branch K1_A_TOP
K1_B_MAX:
    v_max3_f32 v0, v120, v121, v122
    v_max3_f32 v7, v123, v124, v125
    v_max3_f32 v0, v0, v126, v127
    v_max3_f32 v7, v7, v128, v129
    v_max3_f32 v0, v0, v130, v131
    v_max3_f32 v7, v7, v132, v133
    v_max3_f32 v0, v0, v134, v135
    v_max_f32 v0, v0, v7
    v_cmp_lt_f32 vcc, s54, v0
    s_cbranch_vccz K1_B_CONT
K1_B_RARE:
    v_mov_b32 v7, v0
    s_nop 1
    v_permlane32_swap_b32 v0, v7
    v_max_f32 v0, v0, v7
    v_max_f32 v0, s55, v0
    v_max_f32 v7, 0, v0
    v_sub_f32 v7, 0, v7
    v_exp_f32 v7, v7
    s_mov_b32 s54, 0x41000000
    s_mov_b32 s55, 0
    v_sub_f32 v120, v120, v0
    v_sub_f32 v121, v121, v0
    v_sub_f32 v122, v122, v0
    v_sub_f32 v123, v123, v0
    v_sub_f32 v124, v124, v0
    v_sub_f32 v125, v125, v0
    v_sub_f32 v126, v126, v0
    v_sub_f32 v127, v127, v0
    v_sub_f32 v128, v128, v0
    v_sub_f32 v129, v129, v0
    v_sub_f32 v130, v130, v0
    v_sub_f32 v131, v131, v0
    v_sub_f32 v132, v132, v0
    v_sub_f32 v133, v133, v0
    v_sub_f32 v134, v134, v0
    v_sub_f32 v135, v135, v0
    v_sub_f32 v8, v8, v0
    v_mov_b32 v9, v8
    v_mov_b32 v10, v8
    v_mov_b32 v11, v8
    v_mov_b32 v12, v8
    v_mov_b32 v13, v8
    v_mov_b32 v14, v8
    v_mov_b32 v15, v8
    v_mov_b32 v16, v8
    v_mov_b32 v17, v8
    v_mov_b32 v18, v8
    v_mov_b32 v19, v8
    v_mov_b32 v20, v8
    v_mov_b32 v21, v8
    v_mov_b32 v22, v8
    v_mov_b32 v23, v8
    s_cmp_eq_u32 s64, 0
    s_cbranch_scc1 K1_B_CONT
    v_mul_f32 v1, v1, v7
    v_mul_f32 v24, v24, v7
    v_mul_f32 v25, v25, v7
    v_mul_f32 v26, v26, v7
    v_mul_f32 v27, v27, v7
    v_mul_f32 v28, v28, v7
    v_mul_f32 v29, v29, v7
    v_mul_f32 v30, v30, v7
    v_mul_f32 v31, v31, v7
    v_mul_f32 v32, v32, v7
    v_mul_f32 v33, v33, v7
    v_mul_f32 v34, v34, v7
    v_mul_f32 v35, v35, v7
    v_mul_f32 v36, v36, v7
    v_mul_f32 v37, v37, v7
    v_mul_f32 v38, v38, v7
    v_mul_f32 v39, v39, v7
    v_mul_f32 v40, v40, v7
    v_mul_f32 v41, v41, v7
    v_mul_f32 v42, v42, v7
    v_mul_f32 v43, v43, v7
    v_mul_f32 v44, v44, v7
    v_mul_f32 v45, v45, v7
    v_mul_f32 v46, v46, v7
    v_mul_f32 v47, v47, v7
    v_mul_f32 v48, v48, v7
    v_mul_f32 v49, v49, v7
    v_mul_f32 v50, v50, v7
    v_mul_f32 v51, v51, v7
    v_mul_f32 v52, v52, v7
    v_mul_f32 v53, v53, v7
    v_mul_f32 v54, v54, v7
    v_mul_f32 v55, v55, v7
    v_mul_f32 v56, v56, v7
    v_mul_f32 v57, v57, v7
    v_mul_f32 v58, v58, v7
    v_mul_f32 v59, v59, v7
    v_mul_f32 v60, v60, v7
    v_mul_f32 v61, v61, v7
    v_mul_f32 v62, v62, v7
    v_mul_f32 v63, v63, v7
    v_mul_f32 v64, v64, v7
    v_mul_f32 v65, v65, v7
    v_mul_f32 v66, v66, v7
    v_mul_f32 v67, v67, v7
    v_mul_f32 v68, v68, v7
    v_mul_f32 v69, v69, v7
    v_mul_f32 v70, v70, v7
    v_mul_f32 v71, v71, v7
    v_mul_f32 v72, v72, v7
    v_mul_f32 v73, v73, v7
    v_mul_f32 v74, v74, v7
    v_mul_f32 v75, v75, v7
    v_mul_f32 v76, v76, v7
    v_mul_f32 v77, v77, v7
    v_mul_f32 v78, v78, v7
    v_mul_f32 v79, v79, v7
    v_mul_f32 v80, v80, v7
    v_mul_f32 v81, v81, v7
    v_mul_f32 v82, v82, v7
    v_mul_f32 v83, v83, v7
    v_mul_f32 v84, v84, v7
    v_mul_f32 v85, v85, v7
    v_mul_f32 v86, v86, v7
    v_mul_f32 v87, v87, v7
    s_branch K1_B_CONT
K1_A_TOP:
    s_waitcnt lgkmcnt(0)
K1_A_BAR:
    s_setprio 2
    s_barrier
    v_mfma_f32_32x32x16_bf16 v[120:135], v[136:139], v[88:91], v[8:23]
    ds_read_b64_tr_b16 v[136:137], v4 offset:0
    ds_read_b64_tr_b16 v[138:139], v4 offset:2048
    v_add_u32 v2, s76, v2
    v_add_u32 v3, s76, v3
    s_mov_b32 s76, s68
    v_mfma_f32_32x32x16_bf16 v[120:135], v[140:143], v[92:95], v[120:135]
    ds_read_b64_tr_b16 v[140:141], v4 offset:256
    ds_read_b64_tr_b16 v[142:143], v4 offset:2304
    v_mfma_f32_32x32x16_bf16 v[120:135], v[144:147], v[96:99], v[120:135]
    ds_read_b64_tr_b16 v[144:145], v4 offset:512
    ds_read_b64_tr_b16 v[146:147], v4 offset:2560
    s_add_u32 s68, s68, 65536
    s_cmp_ge_u32 s68, 163840
    s_cselect_b32 s72, 163840, 0
    s_sub_u32 s68, s68, s72
    v_mfma_f32_32x32x16_bf16 v[120:135], v[148:151], v[100:103], v[120:135]
    ds_read_b64_tr_b16 v[148:149], v4 offset:768
    ds_read_b64_tr_b16 v[150:151], v4 offset:2816
    v_mfma_f32_32x32x16_bf16 v[120:135], v[152:155], v[104:107], v[120:135]
    ds_read_b64_tr_b16 v[152:153], v4 offset:4096
    ds_read_b64_tr_b16 v[154:155], v4 offset:6144
    s_sub_u32 s76, s68, s76
    s_mov_b32 s77, s69
    s_add_u32 s69, s69, 65536
    s_cmp_ge_u32 s69, 163840
    s_cselect_b32 s72, 163840, 0
    s_sub_u32 s69, s69, s72
    v_mfma_f32_32x32x16_bf16 v[120:135], v[156:159], v[108:111], v[120:135]
    ds_read_b64_tr_b16 v[156:157], v4 offset:4352
    ds_read_b64_tr_b16 v[158:159], v4 offset:6400
    v_mfma_f32_32x32x16_bf16 v[120:135], v[160:163], v[112:115], v[120:135]
    ds_read_b64_tr_b16 v[160:161], v4 offset:4608
    ds_read_b64_tr_b16 v[162:163], v4 offset:6656
    v_mfma_f32_32x32x16_bf16 v[120:135], v[164:167], v[116:119], v[120:135]
    s_setprio 1
    ds_read_b64_tr_b16 v[164:165], v4 offset:4864
    ds_read_b64_tr_b16 v[166:167], v4 offset:6912
    s_sub_u32 s77, s69, s77
    v_add_u32 v4, s77, v4
    s_nop 6
    s_cmp_lt_u32 s64, s44
    s_cbranch_scc1 K1_A_MAX
K1_A_CONT:
    v_exp_f32 v120, v120
    v_exp_f32 v121, v121
    v_exp_f32 v122, v122
    v_exp_f32 v123, v123
    v_add_f32 v1, v1, v120
    v_add_f32 v1, v1, v121
    v_cvt_pk_bf16_f32 v120, v120, v121
    v_exp_f32 v124, v124
    v_exp_f32 v125, v125
    v_add_f32 v1, v1, v122
    v_add_f32 v1, v1, v123
    v_cvt_pk_bf16_f32 v121, v122, v123
    v_exp_f32 v126, v126
    v_exp_f32 v127, v127
    v_add_f32 v1, v1, v124
    v_add_f32 v1, v1, v125
    v_cvt_pk_bf16_f32 v122, v124, v125
    v_exp_f32 v128, v128
    v_exp_f32 v129, v129
    v_add_f32 v1, v1, v126
    v_add_f32 v1, v1, v127
    v_cvt_pk_bf16_f32 v123, v126, v127
    v_exp_f32 v130, v130
    v_exp_f32 v131, v131
    v_add_f32 v1, v1, v128
    v_add_f32 v1, v1, v129
    v_cvt_pk_bf16_f32 v124, v128, v129
    v_exp_f32 v132, v132
    v_exp_f32 v133, v133
    v_add_f32 v1, v1, v130
    v_add_f32 v1, v1, v131
    v_cvt_pk_bf16_f32 v125, v130, v131
    v_exp_f32 v134, v134
    v_exp_f32 v135, v135
    v_add_f32 v1, v1, v132
    v_add_f32 v1, v1, v133
    v_cvt_pk_bf16_f32 v126, v132, v133
    v_add_f32 v1, v1, v134
    v_add_f32 v1, v1, v135
    v_cvt_pk_bf16_f32 v127, v134, v135
    s_setprio 0
    s_waitcnt lgkmcnt(0)
    v_mfma_f32_32x32x16_bf16 v[24:39], v[136:139], v[120:123], v[24:39]
    ds_read_b128 v[136:139], v2 offset:0
    v_mfma_f32_32x32x16_bf16 v[40:55], v[140:143], v[120:123], v[40:55]
    ds_read_b128 v[140:143], v3 offset:0
    v_mfma_f32_32x32x16_bf16 v[56:71], v[144:147], v[120:123], v[56:71]
    ds_read_b128 v[144:147], v2 offset:256
    v_mfma_f32_32x32x16_bf16 v[72:87], v[148:151], v[120:123], v[72:87]
    ds_read_b128 v[148:151], v3 offset:256
    v_mfma_f32_32x32x16_bf16 v[24:39], v[152:155], v[124:127], v[24:39]
    ds_read_b128 v[152:155], v2 offset:512
    s_add_u32 s64, s64, 1
    v_mfma_f32_32x32x16_bf16 v[40:55], v[156:159], v[124:127], v[40:55]
    ds_read_b128 v[156:159], v3 offset:512
    v_mfma_f32_32x32x16_bf16 v[56:71], v[160:163], v[124:127], v[56:71]
    ds_read_b128 v[160:163], v2 offset:768
    v_mfma_f32_32x32x16_bf16 v[72:87], v[164:167], v[124:127], v[72:87]
    ds_read_b128 v[164:167], v3 offset:768
    s_cmp_ge_u32 s64, 8
    s_cbranch_scc1 K1_P2_END
    s_cmp_lt_u32 s4, 4
    s_cbranch_scc1 K1_A_TOP
    s_waitcnt vmcnt(0)
    s_cmp_eq_u32 s6, 0
    s_cselect_b64 s[40:41], s[36:37], s[50:51]
    s_mov_b32 s42, 8388608
    v_mbcnt_lo_u32_b32 v0, -1, 0
    v_mbcnt_hi_u32_b32 v0, -1, v0
    v_lshlrev_b32 v0, 7, v0
    s_lshr_b32 s72, s2, 3
    s_lshl_b32 s72, s72, 3
    s_add_u32 s72, s72, s4
    s_sub_u32 s72, s72, 4
    s_lshl_b32 s72, s72, 13
    s_lshl_b32 s73, s5, 21
    s_add_u32 s72, s72, s73
    buffer_load_dword v6, v0, s[40:43], s72 offen
    s_branch K1_A_TOP
K1_A_MAX:
    v_max3_f32 v0, v120, v121, v122
    v_max3_f32 v7, v123, v124, v125
    v_max3_f32 v0, v0, v126, v127
    v_max3_f32 v7, v7, v128, v129
    v_max3_f32 v0, v0, v130, v131
    v_max3_f32 v7, v7, v132, v133
    v_max3_f32 v0, v0, v134, v135
    v_max_f32 v0, v0, v7
    v_cmp_lt_f32 vcc, s54, v0
    s_cbranch_vccz K1_A_CONT
K1_A_RARE:
    v_mov_b32 v7, v0
    s_nop 1
    v_permlane32_swap_b32 v0, v7
    v_max_f32 v0, v0, v7
    v_max_f32 v0, s55, v0
    v_max_f32 v7, 0, v0
    v_sub_f32 v7, 0, v7
    v_exp_f32 v7, v7
    s_mov_b32 s54, 0x41000000
    s_mov_b32 s55, 0
    v_sub_f32 v120, v120, v0
    v_sub_f32 v121, v121, v0
    v_sub_f32 v122, v122, v0
    v_sub_f32 v123, v123, v0
    v_sub_f32 v124, v124, v0
    v_sub_f32 v125, v125, v0
    v_sub_f32 v126, v126, v0
    v_sub_f32 v127, v127, v0
    v_sub_f32 v128, v128, v0
    v_sub_f32 v129, v129, v0
    v_sub_f32 v130, v130, v0
    v_sub_f32 v131, v131, v0
    v_sub_f32 v132, v132, v0
    v_sub_f32 v133, v133, v0
    v_sub_f32 v134, v134, v0
    v_sub_f32 v135, v135, v0
    v_sub_f32 v8, v8, v0
    v_mov_b32 v9, v8
    v_mov_b32 v10, v8
    v_mov_b32 v11, v8
    v_mov_b32 v12, v8
    v_mov_b32 v13, v8
    v_mov_b32 v14, v8
    v_mov_b32 v15, v8
    v_mov_b32 v16, v8
    v_mov_b32 v17, v8
    v_mov_b32 v18, v8
    v_mov_b32 v19, v8
    v_mov_b32 v20, v8
    v_mov_b32 v21, v8
    v_mov_b32 v22, v8
    v_mov_b32 v23, v8
    s_cmp_eq_u32 s64, 0
    s_cbranch_scc1 K1_A_CONT
    v_mul_f32 v1, v1, v7
    v_mul_f32 v24, v24, v7
    v_mul_f32 v25, v25, v7
    v_mul_f32 v26, v26, v7
    v_mul_f32 v27, v27, v7
    v_mul_f32 v28, v28, v7
    v_mul_f32 v29, v29, v7
    v_mul_f32 v30, v30, v7
    v_mul_f32 v31, v31, v7
    v_mul_f32 v32, v32, v7
    v_mul_f32 v33, v33, v7
    v_mul_f32 v34, v34, v7
    v_mul_f32 v35, v35, v7
    v_mul_f32 v36, v36, v7
    v_mul_f32 v37, v37, v7
    v_mul_f32 v38, v38, v7
    v_mul_f32 v39, v39, v7
    v_mul_f32 v40, v40, v7
    v_mul_f32 v41, v41, v7
    v_mul_f32 v42, v42, v7
    v_mul_f32 v43, v43, v7
    v_mul_f32 v44, v44, v7
    v_mul_f32 v45, v45, v7
    v_mul_f32 v46, v46, v7
    v_mul_f32 v47, v47, v7
    v_mul_f32 v48, v48, v7
    v_mul_f32 v49, v49, v7
    v_mul_f32 v50, v50, v7
    v_mul_f32 v51, v51, v7
    v_mul_f32 v52, v52, v7
    v_mul_f32 v53, v53, v7
    v_mul_f32 v54, v54, v7
    v_mul_f32 v55, v55, v7
    v_mul_f32 v56, v56, v7
    v_mul_f32 v57, v57, v7
    v_mul_f32 v58, v58, v7
    v_mul_f32 v59, v59, v7
    v_mul_f32 v60, v60, v7
    v_mul_f32 v61, v61, v7
    v_mul_f32 v62, v62, v7
    v_mul_f32 v63, v63, v7
    v_mul_f32 v64, v64, v7
    v_mul_f32 v65, v65, v7
    v_mul_f32 v66, v66, v7
    v_mul_f32 v67, v67, v7
    v_mul_f32 v68, v68, v7
    v_mul_f32 v69, v69, v7
    v_mul_f32 v70, v70, v7
    v_mul_f32 v71, v71, v7
    v_mul_f32 v72, v72, v7
    v_mul_f32 v73, v73, v7
    v_mul_f32 v74, v74, v7
    v_mul_f32 v75, v75, v7
    v_mul_f32 v76, v76, v7
    v_mul_f32 v77, v77, v7
    v_mul_f32 v78, v78, v7
    v_mul_f32 v79, v79, v7
    v_mul_f32 v80, v80, v7
    v_mul_f32 v81, v81, v7
    v_mul_f32 v82, v82, v7
    v_mul_f32 v83, v83, v7
    v_mul_f32 v84, v84, v7
    v_mul_f32 v85, v85, v7
    v_mul_f32 v86, v86, v7
    v_mul_f32 v87, v87, v7
    s_branch K1_A_CONT
K1_REDO:
    s_waitcnt vmcnt(0) lgkmcnt(0)
    v_mbcnt_lo_u32_b32 v0, -1, 0
    v_mbcnt_hi_u32_b32 v0, -1, v0
    s_barrier
    v_bfe_u32 v8, v0, 2, 2
    v_lshlrev_b32 v8, 8, v8
    v_lshrrev_b32 v9, 4, v0
    v_lshl_add_u32 v8, v9, 6, v8
    v_and_b32 v9, 3, v0
    v_lshl_add_u32 v6, v9, 4, v8
    s_lshl_b32 s73, s71, 4
    v_xor_b32 v5, s73, v6
    v_and_b32 v8, 31, v0
    v_lshrrev_b32 v9, 5, v0
    v_and_b32 v10, 15, v0
    v_xor_b32 v10, v9, v10
    v_lshlrev_b32 v10, 4, v10
    v_lshl_add_u32 v10, v8, 8, v10
    s_lshl_b32 s72, s70, 13
    s_add_u32 s72, s72, 131072
    v_add_u32 v7, s72, v10
    v_lshrrev_b32 v10, 2, v8
    v_and_b32 v11, 3, v10
    v_xor_b32 v11, v9, v11
    v_lshlrev_b32 v11, 4, v11
    v_lshl_add_u32 v11, v10, 10, v11
    v_and_b32 v10, 3, v0
    v_lshl_add_u32 v11, v10, 6, v11
    s_lshl_b32 s72, s71, 13
    v_add_u32 v2, s72, v11
    v_xor_b32 v3, 32, v2
    v_bfe_u32 v10, v0, 2, 2
    v_lshlrev_b32 v10, 6, v10
    v_lshl_add_u32 v10, v9, 10, v10
    v_bfe_u32 v11, v0, 4, 1
    v_lshl_add_u32 v10, v11, 5, v10
    v_bfe_u32 v11, v0, 1, 1
    v_lshl_add_u32 v10, v11, 4, v10
    v_and_b32 v11, 1, v0
    v_lshl_add_u32 v10, v11, 3, v10
    s_add_u32 s72, s72, 32768
    v_add_u32 v4, s72, v10
    s_sub_u32 s72, s70, 1
    s_lshl_b32 s72, s72, 1
    s_add_u32 s72, s72, 0
    s_add_u32 s73, s71, 0
    s_lshl_b32 s73, s73, 10
    s_lshl_b32 s74, s72, 16
    s_add_u32 s56, s74, s73
    s_lshl_b32 s74, s72, 13
    s_add_u32 s60, s74, s73
    s_sub_u32 s72, s70, 1
    s_lshl_b32 s72, s72, 1
    s_add_u32 s72, s72, 0
    s_add_u32 s73, s71, 4
    s_lshl_b32 s73, s73, 10
    s_lshl_b32 s74, s72, 16
    s_add_u32 s57, s74, s73
    s_lshl_b32 s74, s72, 13
    s_add_u32 s61, s74, s73
    s_sub_u32 s72, s70, 1
    s_lshl_b32 s72, s72, 1
    s_add_u32 s72, s72, 1
    s_add_u32 s73, s71, 0
    s_lshl_b32 s73, s73, 10
    s_lshl_b32 s74, s72, 16
    s_add_u32 s58, s74, s73
    s_lshl_b32 s74, s72, 13
    s_add_u32 s62, s74, s73
    s_sub_u32 s72, s70, 1
    s_lshl_b32 s72, s72, 1
    s_add_u32 s72, s72, 1
    s_add_u32 s73, s71, 4
    s_lshl_b32 s73, s73, 10
    s_lshl_b32 s74, s72, 16
    s_add_u32 s59, s74, s73
    s_lshl_b32 s74, s72, 13
    s_add_u32 s63, s74, s73
    s_mov_b32 s64, 0
    s_mov_b32 s66, 131072
    s_mov_b32 s65, 0
    s_mov_b32 s67, 16384
    s_mov_b32 s68, 65536
    s_mov_b32 s69, 32768
    s_mov_b32 s54, 0xff800000
    s_mov_b32 s55, 0xff800000
    s_mov_b32 s44, 0
    v_mov_b64 v[8:9], 0
    v_mov_b64 v[10:11], 0
    v_mov_b64 v[12:13], 0
    v_mov_b64 v[14:15], 0
    v_mov_b64 v[16:17], 0
    v_mov_b64 v[18:19], 0
    v_mov_b64 v[20:21], 0
    v_mov_b64 v[22:23], 0
    s_mov_b32 s44, 8
    s_cmp_lt_u32 s4, 8
    s_cbranch_scc1 K1_REDO2
    s_lshl_b32 s73, s75, 10
    s_add_u32 m0, s73, 0
    s_add_u32 s72, s73, 0
    buffer_load_dwordx4 v5, s[16:19], s72 offen lds
    s_add_u32 m0, s73, 4096
    s_add_u32 s72, s73, 4096
    buffer_load_dwordx4 v5, s[16:19], s72 offen lds
    s_add_u32 m0, s73, 8192
    s_add_u32 s72, s73, 65536
    buffer_load_dwordx4 v5, s[16:19], s72 offen lds
    s_add_u32 m0, s73, 12288
    s_add_u32 s72, s73, 69632
    buffer_load_dwordx4 v5, s[16:19], s72 offen lds
    s_add_u32 m0, s73, 16384
    s_add_u32 s72, s73, 131072
    buffer_load_dwordx4 v5, s[16:19], s72 offen lds
    s_add_u32 m0, s73, 20480
    s_add_u32 s72, s73, 135168
    buffer_load_dwordx4 v5, s[16:19], s72 offen lds
    s_add_u32 m0, s73, 24576
    s_add_u32 s72, s73, 196608
    buffer_load_dwordx4 v5, s[16:19], s72 offen lds
    s_add_u32 m0, s73, 28672
    s_add_u32 s72, s73, 200704
    buffer_load_dwordx4 v5, s[16:19], s72 offen lds
    s_lshl_b32 s73, s75, 10
    s_add_u32 m0, s73, 32768
    s_add_u32 s72, s73, 0
    buffer_load_dwordx4 v6, s[20:23], s72 offen lds
    s_add_u32 m0, s73, 36864
    s_add_u32 s72, s73, 4096
    buffer_load_dwordx4 v6, s[20:23], s72 offen lds
    s_add_u32 m0, s73, 40960
    s_add_u32 s72, s73, 65536
    buffer_load_dwordx4 v6, s[20:23], s72 offen lds
    s_add_u32 m0, s73, 45056
    s_add_u32 s72, s73, 69632
    buffer_load_dwordx4 v6, s[20:23], s72 offen lds
    s_add_u32 m0, s73, 49152
    s_add_u32 s72, s73, 131072
    buffer_load_dwordx4 v6, s[20:23], s72 offen lds
    s_add_u32 m0, s73, 53248
    s_add_u32 s72, s73, 135168
    buffer_load_dwordx4 v6, s[20:23], s72 offen lds
    s_add_u32 m0, s73, 57344
    s_add_u32 s72, s73, 196608
    buffer_load_dwordx4 v6, s[20:23], s72 offen lds
    s_add_u32 m0, s73, 61440
    s_add_u32 s72, s73, 200704
    buffer_load_dwordx4 v6, s[20:23], s72 offen lds
    s_lshl_b32 s73, s75, 10
    s_add_u32 m0, s73, 65536
    s_add_u32 s72, s73, 8192
    buffer_load_dwordx4 v5, s[16:19], s72 offen lds
    s_add_u32 m0, s73, 69632
    s_add_u32 s72, s73, 12288
    buffer_load_dwordx4 v5, s[16:19], s72 offen lds
    s_add_u32 m0, s73, 73728
    s_add_u32 s72, s73, 73728
    buffer_load_dwordx4 v5, s[16:19], s72 offen lds
    s_add_u32 m0, s73, 77824
    s_add_u32 s72, s73, 77824
    buffer_load_dwordx4 v5, s[16:19], s72 offen lds
    s_add_u32 m0, s73, 81920
    s_add_u32 s72, s73, 139264
    buffer_load_dwordx4 v5, s[16:19], s72 offen lds
    s_add_u32 m0, s73, 86016
    s_add_u32 s72, s73, 143360
    buffer_load_dwordx4 v5, s[16:19], s72 offen lds
    s_add_u32 m0, s73, 90112
    s_add_u32 s72, s73, 204800
    buffer_load_dwordx4 v5, s[16:19], s72 offen lds
    s_add_u32 m0, s73, 94208
    s_add_u32 s72, s73, 208896
    buffer_load_dwordx4 v5, s[16:19], s72 offen lds
    s_lshl_b32 s73, s75, 10
    s_add_u32 m0, s73, 98304
    s_add_u32 s72, s73, 8192
    buffer_load_dwordx4 v6, s[20:23], s72 offen lds
    s_add_u32 m0, s73, 102400
    s_add_u32 s72, s73, 12288
    buffer_load_dwordx4 v6, s[20:23], s72 offen lds
    s_add_u32 m0, s73, 106496
    s_add_u32 s72, s73, 73728
    buffer_load_dwordx4 v6, s[20:23], s72 offen lds
    s_add_u32 m0, s73, 110592
    s_add_u32 s72, s73, 77824
    buffer_load_dwordx4 v6, s[20:23], s72 offen lds
    s_add_u32 m0, s73, 114688
    s_add_u32 s72, s73, 139264
    buffer_load_dwordx4 v6, s[20:23], s72 offen lds
    s_add_u32 m0, s73, 118784
    s_add_u32 s72, s73, 143360
    buffer_load_dwordx4 v6, s[20:23], s72 offen lds
    s_add_u32 m0, s73, 122880
    s_add_u32 s72, s73, 204800
    buffer_load_dwordx4 v6, s[20:23], s72 offen lds
    s_add_u32 m0, s73, 126976
    s_add_u32 s72, s73, 208896
    buffer_load_dwordx4 v6, s[20:23], s72 offen lds
    s_waitcnt vmcnt(8)
K1_REDO2:
    s_barrier
    ds_read_b128 v[136:139], v2 offset:0
    ds_read_b128 v[140:143], v3 offset:0
    ds_read_b128 v[144:147], v2 offset:256
    ds_read_b128 v[148:151], v3 offset:256
    ds_read_b128 v[152:155], v2 offset:512
    ds_read_b128 v[156:159], v3 offset:512
    ds_read_b128 v[160:163], v2 offset:768
    ds_read_b128 v[164:167], v3 offset:768
    s_branch K1_JOIN2
K1_P2_END:
    s_load_dwordx2 s[48:49], s[0:1], 80
    v_mbcnt_lo_u32_b32 v15, -1, 0
    v_mbcnt_hi_u32_b32 v15, -1, v15
    s_cmp_lg_u32 s44, 0
    s_cbranch_scc1 K1_COMB_GEN
    v_mov_b32 v11, v1
    v_lshlrev_b32 v12, 4, v15
    s_nop 0
    v_permlane32_swap_b32 v1, v11
    s_nop 0
    v_add_f32 v1, v1, v11
    v_cmp_ngt_f32 vcc, 0x49800000, v1
    v_and_b32 v10, 31, v15
    s_nop 0
    s_mov_b64 s[82:83], vcc
    v_cmp_nlt_f32 vcc, 0x35800000, v1
    s_nop 1
    s_or_b64 vcc, vcc, s[82:83]
    s_cmp_lg_u64 vcc, 0
    s_cselect_b32 s74, 1, 0
    v_lshlrev_b32 v10, 4, v10
    s_lshl_b32 s72, s70, 9
    s_add_u32 s72, s72, 61440
    v_add_u32 v10, s72, v10
    s_lshl_b32 s72, s71, 2
    v_add_u32 v13, s72, v10
    ds_write_b32 v13, v1
    s_lshl_b32 s72, s4, 2
    s_add_u32 s72, s72, 64512
    v_mov_b32 v13, s72
    v_mov_b32 v14, s74
    ds_write_b32 v13, v14
    s_waitcnt lgkmcnt(0)
    v_and_b32 v13, 3, v15
    v_lshlrev_b32 v13, 4, v13
    v_mov_b32 v16, 0x3f80
    v_mov_b32 v17, 0
    v_lshlrev_b64 v[16:17], v13, v[16:17]
    v_mov_b64 v[120:121], 0
    v_mov_b64 v[122:123], 0
    v_mov_b64 v[124:125], 0
    v_mov_b64 v[126:127], 0
    s_mov_b32 exec_lo, 0xf
    s_mov_b32 exec_hi, 0xf0
    v_mov_b64 v[120:121], v[16:17]
    s_mov_b32 exec_lo, 0xf00
    s_mov_b32 exec_hi, 0xf000
    v_mov_b64 v[122:123], v[16:17]
    s_mov_b32 exec_lo, 0xf0000
    s_mov_b32 exec_hi, 0xf00000
    v_mov_b64 v[124:125], v[16:17]
    s_mov_b32 exec_lo, 0xf000000
    s_mov_b32 exec_hi, 0xf0000000
    v_mov_b64 v[126:127], v[16:17]
    s_mov_b64 exec, -1
    s_mul_i32 s73, s70, 24576
    s_add_u32 s73, s73, 65536
    v_add_u32 v11, s73, v12
    s_cmp_eq_u32 s71, 1
    s_cbranch_scc1 K1_CV1
    s_cmp_eq_u32 s71, 2
    s_cbranch_scc1 K1_CV2
    s_cmp_eq_u32 s71, 3
    s_cbranch_scc1 K1_CV3
K1_CV0:
    v_cvt_pk_bf16_f32 v136, v40, v41
    v_cvt_pk_bf16_f32 v137, v42, v43
    v_cvt_pk_bf16_f32 v138, v44, v45
    v_cvt_pk_bf16_f32 v139, v46, v47
    v_cvt_pk_bf16_f32 v140, v48, v49
    v_cvt_pk_bf16_f32 v141, v50, v51
    v_cvt_pk_bf16_f32 v142, v52, v53
    v_cvt_pk_bf16_f32 v143, v54, v55
    ds_write_b128 v11, v[136:139] offset:10240
    ds_write_b128 v11, v[140:143] offset:11264
    v_cvt_pk_bf16_f32 v144, v56, v57
    v_cvt_pk_bf16_f32 v145, v58, v59
    v_cvt_pk_bf16_f32 v146, v60, v61
    v_cvt_pk_bf16_f32 v147, v62, v63
    v_cvt_pk_bf16_f32 v148, v64, v65
    v_cvt_pk_bf16_f32 v149, v66, v67
    v_cvt_pk_bf16_f32 v150, v68, v69
    v_cvt_pk_bf16_f32 v151, v70, v71
    ds_write_b128 v11, v[144:147] offset:14336
    ds_write_b128 v11, v[148:151] offset:15360
    v_cvt_pk_bf16_f32 v152, v72, v73
    v_cvt_pk_bf16_f32 v153, v74, v75
    v_cvt_pk_bf16_f32 v154, v76, v77
    v_cvt_pk_bf16_f32 v155, v78, v79
    v_cvt_pk_bf16_f32 v156, v80, v81
    v_cvt_pk_bf16_f32 v157, v82, v83
    v_cvt_pk_bf16_f32 v158, v84, v85
    v_cvt_pk_bf16_f32 v159, v86, v87
    ds_write_b128 v11, v[152:155] offset:18432
    ds_write_b128 v11, v[156:159] offset:19456
    v_mov_b32 v13, 64512
    s_waitcnt lgkmcnt(0)
    s_barrier
    ds_read_b128 v[136:139], v13 offset:0
    ds_read_b128 v[140:143], v13 offset:16
    ds_read_b128 v[144:147], v13 offset:32
    ds_read_b128 v[148:151], v10
    ds_read_b128 v[40:43], v11 offset:0
    ds_read_b128 v[44:47], v11 offset:1024
    ds_read_b128 v[48:51], v11 offset:2048
    ds_read_b128 v[52:55], v11 offset:3072
    ds_read_b128 v[56:59], v11 offset:4096
    ds_read_b128 v[60:63], v11 offset:5120
    s_waitcnt lgkmcnt(6)
    v_or3_b32 v136, v136, v137, v138
    v_or3_b32 v139, v139, v140, v141
    v_or3_b32 v142, v142, v143, v144
    v_or3_b32 v145, v145, v146, v147
    v_or3_b32 v136, v136, v139, v142
    v_or_b32 v136, v136, v145
    v_cmp_ne_u32 vcc, 0, v136
    s_cbranch_vccnz K1_REDO
    v_add_f32 v148, v148, v149
    v_add_f32 v150, v150, v151
    v_add_f32 v148, v148, v150
    v_rcp_f32 v148, v148
    s_waitcnt lgkmcnt(5)
    v_mfma_f32_32x32x16_bf16 v[24:39], v[120:123], v[40:43], v[24:39]
    s_waitcnt lgkmcnt(4)
    v_mfma_f32_32x32x16_bf16 v[24:39], v[124:127], v[44:47], v[24:39]
    s_waitcnt lgkmcnt(3)
    v_mfma_f32_32x32x16_bf16 v[24:39], v[120:123], v[48:51], v[24:39]
    s_waitcnt lgkmcnt(2)
    v_mfma_f32_32x32x16_bf16 v[24:39], v[124:127], v[52:55], v[24:39]
    s_waitcnt lgkmcnt(1)
    v_mfma_f32_32x32x16_bf16 v[24:39], v[120:123], v[56:59], v[24:39]
    s_waitcnt lgkmcnt(0)
    v_mfma_f32_32x32x16_bf16 v[24:39], v[124:127], v[60:63], v[24:39]
    s_nop 15
    s_nop 3
    v_pk_mul_f32 v[24:25], v[24:25], v[148:149] op_sel_hi:[1,0]
    v_pk_mul_f32 v[26:27], v[26:27], v[148:149] op_sel_hi:[1,0]
    v_pk_mul_f32 v[28:29], v[28:29], v[148:149] op_sel_hi:[1,0]
    v_pk_mul_f32 v[30:31], v[30:31], v[148:149] op_sel_hi:[1,0]
    v_pk_mul_f32 v[32:33], v[32:33], v[148:149] op_sel_hi:[1,0]
    v_pk_mul_f32 v[34:35], v[34:35], v[148:149] op_sel_hi:[1,0]
    v_pk_mul_f32 v[36:37], v[36:37], v[148:149] op_sel_hi:[1,0]
    v_pk_mul_f32 v[38:39], v[38:39], v[148:149] op_sel_hi:[1,0]
    v_cvt_pk_bf16_f32 v136, v24, v25
    v_cvt_pk_bf16_f32 v137, v26, v27
    v_cvt_pk_bf16_f32 v138, v28, v29
    v_cvt_pk_bf16_f32 v139, v30, v31
    v_cvt_pk_bf16_f32 v140, v32, v33
    v_cvt_pk_bf16_f32 v141, v34, v35
    v_cvt_pk_bf16_f32 v142, v36, v37
    v_cvt_pk_bf16_f32 v143, v38, v39
    s_branch K1_COMB_DONE
K1_CV1:
    v_cvt_pk_bf16_f32 v136, v24, v25
    v_cvt_pk_bf16_f32 v137, v26, v27
    v_cvt_pk_bf16_f32 v138, v28, v29
    v_cvt_pk_bf16_f32 v139, v30, v31
    v_cvt_pk_bf16_f32 v140, v32, v33
    v_cvt_pk_bf16_f32 v141, v34, v35
    v_cvt_pk_bf16_f32 v142, v36, v37
    v_cvt_pk_bf16_f32 v143, v38, v39
    ds_write_b128 v11, v[136:139] offset:0
    ds_write_b128 v11, v[140:143] offset:1024
    v_cvt_pk_bf16_f32 v144, v56, v57
    v_cvt_pk_bf16_f32 v145, v58, v59
    v_cvt_pk_bf16_f32 v146, v60, v61
    v_cvt_pk_bf16_f32 v147, v62, v63
    v_cvt_pk_bf16_f32 v148, v64, v65
    v_cvt_pk_bf16_f32 v149, v66, v67
    v_cvt_pk_bf16_f32 v150, v68, v69
    v_cvt_pk_bf16_f32 v151, v70, v71
    ds_write_b128 v11, v[144:147] offset:16384
    ds_write_b128 v11, v[148:151] offset:17408
    v_cvt_pk_bf16_f32 v152, v72, v73
    v_cvt_pk_bf16_f32 v153, v74, v75
    v_cvt_pk_bf16_f32 v154, v76, v77
    v_cvt_pk_bf16_f32 v155, v78, v79
    v_cvt_pk_bf16_f32 v156, v80, v81
    v_cvt_pk_bf16_f32 v157, v82, v83
    v_cvt_pk_bf16_f32 v158, v84, v85
    v_cvt_pk_bf16_f32 v159, v86, v87
    ds_write_b128 v11, v[152:155] offset:20480
    ds_write_b128 v11, v[156:159] offset:21504
    v_mov_b32 v13, 64512
    s_waitcnt lgkmcnt(0)
    s_barrier
    ds_read_b128 v[136:139], v13 offset:0
    ds_read_b128 v[140:143], v13 offset:16
    ds_read_b128 v[144:147], v13 offset:32
    ds_read_b128 v[148:151], v10
    ds_read_b128 v[24:27], v11 offset:6144
    ds_read_b128 v[28:31], v11 offset:7168
    ds_read_b128 v[32:35], v11 offset:8192
    ds_read_b128 v[36:39], v11 offset:9216
    ds_read_b128 v[56:59], v11 offset:10240
    ds_read_b128 v[60:63], v11 offset:11264
    s_waitcnt lgkmcnt(6)
    v_or3_b32 v136, v136, v137, v138
    v_or3_b32 v139, v139, v140, v141
    v_or3_b32 v142, v142, v143, v144
    v_or3_b32 v145, v145, v146, v147
    v_or3_b32 v136, v136, v139, v142
    v_or_b32 v136, v136, v145
    v_cmp_ne_u32 vcc, 0, v136
    s_cbranch_vccnz K1_REDO
    v_add_f32 v148, v148, v149
    v_add_f32 v150, v150, v151
    v_add_f32 v148, v148, v150
    v_rcp_f32 v148, v148
    s_waitcnt lgkmcnt(5)
    v_mfma_f32_32x32x16_bf16 v[40:55], v[120:123], v[24:27], v[40:55]
    s_waitcnt lgkmcnt(4)
    v_mfma_f32_32x32x16_bf16 v[40:55], v[124:127], v[28:31], v[40:55]
    s_waitcnt lgkmcnt(3)
    v_mfma_f32_32x32x16_bf16 v[40:55], v[120:123], v[32:35], v[40:55]
    s_waitcnt lgkmcnt(2)
    v_mfma_f32_32x32x16_bf16 v[40:55], v[124:127], v[36:39], v[40:55]
    s_waitcnt lgkmcnt(1)
    v_mfma_f32_32x32x16_bf16 v[40:55], v[120:123], v[56:59], v[40:55]
    s_waitcnt lgkmcnt(0)
    v_mfma_f32_32x32x16_bf16 v[40:55], v[124:127], v[60:63], v[40:55]
    s_nop 15
    s_nop 3
    v_pk_mul_f32 v[40:41], v[40:41], v[148:149] op_sel_hi:[1,0]
    v_pk_mul_f32 v[42:43], v[42:43], v[148:149] op_sel_hi:[1,0]
    v_pk_mul_f32 v[44:45], v[44:45], v[148:149] op_sel_hi:[1,0]
    v_pk_mul_f32 v[46:47], v[46:47], v[148:149] op_sel_hi:[1,0]
    v_pk_mul_f32 v[48:49], v[48:49], v[148:149] op_sel_hi:[1,0]
    v_pk_mul_f32 v[50:51], v[50:51], v[148:149] op_sel_hi:[1,0]
    v_pk_mul_f32 v[52:53], v[52:53], v[148:149] op_sel_hi:[1,0]
    v_pk_mul_f32 v[54:55], v[54:55], v[148:149] op_sel_hi:[1,0]
    v_cvt_pk_bf16_f32 v136, v40, v41
    v_cvt_pk_bf16_f32 v137, v42, v43
    v_cvt_pk_bf16_f32 v138, v44, v45
    v_cvt_pk_bf16_f32 v139, v46, v47
    v_cvt_pk_bf16_f32 v140, v48, v49
    v_cvt_pk_bf16_f32 v141, v50, v51
    v_cvt_pk_bf16_f32 v142, v52, v53
    v_cvt_pk_bf16_f32 v143, v54, v55
    s_branch K1_COMB_DONE
K1_CV2:
    v_cvt_pk_bf16_f32 v136, v24, v25
    v_cvt_pk_bf16_f32 v137, v26, v27
    v_cvt_pk_bf16_f32 v138, v28, v29
    v_cvt_pk_bf16_f32 v139, v30, v31
    v_cvt_pk_bf16_f32 v140, v32, v33
    v_cvt_pk_bf16_f32 v141, v34, v35
    v_cvt_pk_bf16_f32 v142, v36, v37
    v_cvt_pk_bf16_f32 v143, v38, v39
    ds_write_b128 v11, v[136:139] offset:2048
    ds_write_b128 v11, v[140:143] offset:3072
    v_cvt_pk_bf16_f32 v144, v40, v41
    v_cvt_pk_bf16_f32 v145, v42, v43
    v_cvt_pk_bf16_f32 v146, v44, v45
    v_cvt_pk_bf16_f32 v147, v46, v47
    v_cvt_pk_bf16_f32 v148, v48, v49
    v_cvt_pk_bf16_f32 v149, v50, v51
    v_cvt_pk_bf16_f32 v150, v52, v53
    v_cvt_pk_bf16_f32 v151, v54, v55
    ds_write_b128 v11, v[144:147] offset:6144
    ds_write_b128 v11, v[148:151] offset:7168
    v_cvt_pk_bf16_f32 v152, v72, v73
    v_cvt_pk_bf16_f32 v153, v74, v75
    v_cvt_pk_bf16_f32 v154, v76, v77
    v_cvt_pk_bf16_f32 v155, v78, v79
    v_cvt_pk_bf16_f32 v156, v80, v81
    v_cvt_pk_bf16_f32 v157, v82, v83
    v_cvt_pk_bf16_f32 v158, v84, v85
    v_cvt_pk_bf16_f32 v159, v86, v87
    ds_write_b128 v11, v[152:155] offset:22528
    ds_write_b128 v11, v[156:159] offset:23552
    v_mov_b32 v13, 64512
    s_waitcnt lgkmcnt(0)
    s_barrier
    ds_read_b128 v[136:139], v13 offset:0
    ds_read_b128 v[140:143], v13 offset:16
    ds_read_b128 v[144:147], v13 offset:32
    ds_read_b128 v[148:151], v10
    ds_read_b128 v[24:27], v11 offset:12288
    ds_read_b128 v[28:31], v11 offset:13312
    ds_read_b128 v[32:35], v11 offset:14336
    ds_read_b128 v[36:39], v11 offset:15360
    ds_read_b128 v[40:43], v11 offset:16384
    ds_read_b128 v[44:47], v11 offset:17408
    s_waitcnt lgkmcnt(6)
    v_or3_b32 v136, v136, v137, v138
    v_or3_b32 v139, v139, v140, v141
    v_or3_b32 v142, v142, v143, v144
    v_or3_b32 v145, v145, v146, v147
    v_or3_b32 v136, v136, v139, v142
    v_or_b32 v136, v136, v145
    v_cmp_ne_u32 vcc, 0, v136
    s_cbranch_vccnz K1_REDO
    v_add_f32 v148, v148, v149
    v_add_f32 v150, v150, v151
    v_add_f32 v148, v148, v150
    v_rcp_f32 v148, v148
    s_waitcnt lgkmcnt(5)
    v_mfma_f32_32x32x16_bf16 v[56:71], v[120:123], v[24:27], v[56:71]
    s_waitcnt lgkmcnt(4)
    v_mfma_f32_32x32x16_bf16 v[56:71], v[124:127], v[28:31], v[56:71]
    s_waitcnt lgkmcnt(3)
    v_mfma_f32_32x32x16_bf16 v[56:71], v[120:123], v[32:35], v[56:71]
    s_waitcnt lgkmcnt(2)
    v_mfma_f32_32x32x16_bf16 v[56:71], v[124:127], v[36:39], v[56:71]
    s_waitcnt lgkmcnt(1)
    v_mfma_f32_32x32x16_bf16 v[56:71], v[120:123], v[40:43], v[56:71]
    s_waitcnt lgkmcnt(0)
    v_mfma_f32_32x32x16_bf16 v[56:71], v[124:127], v[44:47], v[56:71]
    s_nop 15
    s_nop 3
    v_pk_mul_f32 v[56:57], v[56:57], v[148:149] op_sel_hi:[1,0]
    v_pk_mul_f32 v[58:59], v[58:59], v[148:149] op_sel_hi:[1,0]
    v_pk_mul_f32 v[60:61], v[60:61], v[148:149] op_sel_hi:[1,0]
    v_pk_mul_f32 v[62:63], v[62:63], v[148:149] op_sel_hi:[1,0]
    v_pk_mul_f32 v[64:65], v[64:65], v[148:149] op_sel_hi:[1,0]
    v_pk_mul_f32 v[66:67], v[66:67], v[148:149] op_sel_hi:[1,0]
    v_pk_mul_f32 v[68:69], v[68:69], v[148:149] op_sel_hi:[1,0]
    v_pk_mul_f32 v[70:71], v[70:71], v[148:149] op_sel_hi:[1,0]
    v_cvt_pk_bf16_f32 v136, v56, v57
    v_cvt_pk_bf16_f32 v137, v58, v59
    v_cvt_pk_bf16_f32 v138, v60, v61
    v_cvt_pk_bf16_f32 v139, v62, v63
    v_cvt_pk_bf16_f32 v140, v64, v65
    v_cvt_pk_bf16_f32 v141, v66, v67
    v_cvt_pk_bf16_f32 v142, v68, v69
    v_cvt_pk_bf16_f32 v143, v70, v71
    s_branch K1_COMB_DONE
K1_CV3:
    v_cvt_pk_bf16_f32 v136, v24, v25
    v_cvt_pk_bf16_f32 v137, v26, v27
    v_cvt_pk_bf16_f32 v138, v28, v29
    v_cvt_pk_bf16_f32 v139, v30, v31
    v_cvt_pk_bf16_f32 v140, v32, v33
    v_cvt_pk_bf16_f32 v141, v34, v35
    v_cvt_pk_bf16_f32 v142, v36, v37
    v_cvt_pk_bf16_f32 v143, v38, v39
    ds_write_b128 v11, v[136:139] offset:4096
    ds_write_b128 v11, v[140:143] offset:5120
    v_cvt_pk_bf16_f32 v144, v40, v41
    v_cvt_pk_bf16_f32 v145, v42, v43
    v_cvt_pk_bf16_f32 v146, v44, v45
    v_cvt_pk_bf16_f32 v147, v46, v47
    v_cvt_pk_bf16_f32 v148, v48, v49
    v_cvt_pk_bf16_f32 v149, v50, v51
    v_cvt_pk_bf16_f32 v150, v52, v53
    v_cvt_pk_bf16_f32 v151, v54, v55
    ds_write_b128 v11, v[144:147] offset:8192
    ds_write_b128 v11, v[148:151] offset:9216
    v_cvt_pk_bf16_f32 v152, v56, v57
    v_cvt_pk_bf16_f32 v153, v58, v59
    v_cvt_pk_bf16_f32 v154, v60, v61
    v_cvt_pk_bf16_f32 v155, v62, v63
    v_cvt_pk_bf16_f32 v156, v64, v65
    v_cvt_pk_bf16_f32 v157, v66, v67
    v_cvt_pk_bf16_f32 v158, v68, v69
    v_cvt_pk_bf16_f32 v159, v70, v71
    ds_write_b128 v11, v[152:155] offset:12288
    ds_write_b128 v11, v[156:159] offset:13312
    v_mov_b32 v13, 64512
    s_waitcnt lgkmcnt(0)
    s_barrier
    ds_read_b128 v[136:139], v13 offset:0
    ds_read_b128 v[140:143], v13 offset:16
    ds_read_b128 v[144:147], v13 offset:32
    ds_read_b128 v[148:151], v10
    ds_read_b128 v[24:27], v11 offset:18432
    ds_read_b128 v[28:31], v11 offset:19456
    ds_read_b128 v[32:35], v11 offset:20480
    ds_read_b128 v[36:39], v11 offset:21504
    ds_read_b128 v[40:43], v11 offset:22528
    ds_read_b128 v[44:47], v11 offset:23552
    s_waitcnt lgkmcnt(6)
    v_or3_b32 v136, v136, v137, v138
    v_or3_b32 v139, v139, v140, v141
    v_or3_b32 v142, v142, v143, v144
    v_or3_b32 v145, v145, v146, v147
    v_or3_b32 v136, v136, v139, v142
    v_or_b32 v136, v136, v145
    v_cmp_ne_u32 vcc, 0, v136
    s_cbranch_vccnz K1_REDO
    v_add_f32 v148, v148, v149
    v_add_f32 v150, v150, v151
    v_add_f32 v148, v148, v150
    v_rcp_f32 v148, v148
    s_waitcnt lgkmcnt(5)
    v_mfma_f32_32x32x16_bf16 v[72:87], v[120:123], v[24:27], v[72:87]
    s_waitcnt lgkmcnt(4)
    v_mfma_f32_32x32x16_bf16 v[72:87], v[124:127], v[28:31], v[72:87]
    s_waitcnt lgkmcnt(3)
    v_mfma_f32_32x32x16_bf16 v[72:87], v[120:123], v[32:35], v[72:87]
    s_waitcnt lgkmcnt(2)
    v_mfma_f32_32x32x16_bf16 v[72:87], v[124:127], v[36:39], v[72:87]
    s_waitcnt lgkmcnt(1)
    v_mfma_f32_32x32x16_bf16 v[72:87], v[120:123], v[40:43], v[72:87]
    s_waitcnt lgkmcnt(0)
    v_mfma_f32_32x32x16_bf16 v[72:87], v[124:127], v[44:47], v[72:87]
    s_nop 15
    s_nop 3
    v_pk_mul_f32 v[72:73], v[72:73], v[148:149] op_sel_hi:[1,0]
    v_pk_mul_f32 v[74:75], v[74:75], v[148:149] op_sel_hi:[1,0]
    v_pk_mul_f32 v[76:77], v[76:77], v[148:149] op_sel_hi:[1,0]
    v_pk_mul_f32 v[78:79], v[78:79], v[148:149] op_sel_hi:[1,0]
    v_pk_mul_f32 v[80:81], v[80:81], v[148:149] op_sel_hi:[1,0]
    v_pk_mul_f32 v[82:83], v[82:83], v[148:149] op_sel_hi:[1,0]
    v_pk_mul_f32 v[84:85], v[84:85], v[148:149] op_sel_hi:[1,0]
    v_pk_mul_f32 v[86:87], v[86:87], v[148:149] op_sel_hi:[1,0]
    v_cvt_pk_bf16_f32 v136, v72, v73
    v_cvt_pk_bf16_f32 v137, v74, v75
    v_cvt_pk_bf16_f32 v138, v76, v77
    v_cvt_pk_bf16_f32 v139, v78, v79
    v_cvt_pk_bf16_f32 v140, v80, v81
    v_cvt_pk_bf16_f32 v141, v82, v83
    v_cvt_pk_bf16_f32 v142, v84, v85
    v_cvt_pk_bf16_f32 v143, v86, v87
    s_branch K1_COMB_DONE
K1_COMB_GEN:
    v_mov_b32 v11, v1
    v_sub_f32 v16, 0, v8
    v_and_b32 v10, 31, v15
    v_permlane32_swap_b32 v1, v11
    v_add_f32 v17, v1, v11
    v_cmp_ngt_f32 vcc, 0x49800000, v17
    s_lshl_b32 s72, s4, 2
    s_add_u32 s72, s72, 64512
    v_mov_b32 v13, s72
    s_cmp_lg_u64 vcc, 0
    s_cselect_b32 s72, 1, 0
    s_cmp_eq_u32 s44, 1
    s_cselect_b32 s72, s72, 0
    v_mov_b32 v14, s72
    ds_write_b32 v13, v14
    v_lshlrev_b32 v10, 3, v10
    s_lshl_b32 s72, s70, 10
    s_add_u32 s72, s72, 61440
    v_add_u32 v10, s72, v10
    s_lshl_b32 s73, s71, 8
    v_add_u32 v11, s73, v10
    v_lshlrev_b32 v12, 4, v15
    s_mul_i32 s73, s70, 24576
    s_add_u32 s73, s73, 65536
    ds_write_b64 v11, v[16:17]
    s_waitcnt lgkmcnt(0)
    s_cmp_eq_u32 s71, 0
    s_cbranch_scc1 K1_OWN0
    s_sub_u32 s72, s71, 1
    s_and_b32 s72, s72, 3
    s_lshl_b32 s72, s72, 11
    s_add_u32 s72, s72, s73
    v_add_u32 v11, s72, v12
    v_cvt_pk_bf16_f32 v136, v24, v25
    v_cvt_pk_bf16_f32 v137, v26, v27
    v_cvt_pk_bf16_f32 v138, v28, v29
    v_cvt_pk_bf16_f32 v139, v30, v31
    v_cvt_pk_bf16_f32 v140, v32, v33
    v_cvt_pk_bf16_f32 v141, v34, v35
    v_cvt_pk_bf16_f32 v142, v36, v37
    v_cvt_pk_bf16_f32 v143, v38, v39
    ds_write_b128 v11, v[136:139] offset:0
    ds_write_b128 v11, v[140:143] offset:1024
    s_branch K1_NXT0
K1_OWN0:
    v_mov_b64 v[120:121], v[24:25]
    v_mov_b64 v[122:123], v[26:27]
    v_mov_b64 v[124:125], v[28:29]
    v_mov_b64 v[126:127], v[30:31]
    v_mov_b64 v[128:129], v[32:33]
    v_mov_b64 v[130:131], v[34:35]
    v_mov_b64 v[132:133], v[36:37]
    v_mov_b64 v[134:135], v[38:39]
K1_NXT0:
    s_cmp_eq_u32 s71, 1
    s_cbranch_scc1 K1_OWN1
    s_sub_u32 s72, s71, 2
    s_and_b32 s72, s72, 3
    s_lshl_b32 s72, s72, 11
    s_add_u32 s72, s72, s73
    v_add_u32 v11, s72, v12
    v_cvt_pk_bf16_f32 v144, v40, v41
    v_cvt_pk_bf16_f32 v145, v42, v43
    v_cvt_pk_bf16_f32 v146, v44, v45
    v_cvt_pk_bf16_f32 v147, v46, v47
    v_cvt_pk_bf16_f32 v148, v48, v49
    v_cvt_pk_bf16_f32 v149, v50, v51
    v_cvt_pk_bf16_f32 v150, v52, v53
    v_cvt_pk_bf16_f32 v151, v54, v55
    ds_write_b128 v11, v[144:147] offset:6144
    ds_write_b128 v11, v[148:151] offset:7168
    s_branch K1_NXT1
K1_OWN1:
    v_mov_b64 v[120:121], v[40:41]
    v_mov_b64 v[122:123], v[42:43]
    v_mov_b64 v[124:125], v[44:45]
    v_mov_b64 v[126:127], v[46:47]
    v_mov_b64 v[128:129], v[48:49]
    v_mov_b64 v[130:131], v[50:51]
    v_mov_b64 v[132:133], v[52:53]
    v_mov_b64 v[134:135], v[54:55]
K1_NXT1:
    s_cmp_eq_u32 s71, 2
    s_cbranch_scc1 K1_OWN2
    s_sub_u32 s72, s71, 3
    s_and_b32 s72, s72, 3
    s_lshl_b32 s72, s72, 11
    s_add_u32 s72, s72, s73
    v_add_u32 v11, s72, v12
    v_cvt_pk_bf16_f32 v152, v56, v57
    v_cvt_pk_bf16_f32 v153, v58, v59
    v_cvt_pk_bf16_f32 v154, v60, v61
    v_cvt_pk_bf16_f32 v155, v62, v63
    v_cvt_pk_bf16_f32 v156, v64, v65
    v_cvt_pk_bf16_f32 v157, v66, v67
    v_cvt_pk_bf16_f32 v158, v68, v69
    v_cvt_pk_bf16_f32 v159, v70, v71
    ds_write_b128 v11, v[152:155] offset:12288
    ds_write_b128 v11, v[156:159] offset:13312
    s_branch K1_NXT2
K1_OWN2:
    v_mov_b64 v[120:121], v[56:57]
    v_mov_b64 v[122:123], v[58:59]
    v_mov_b64 v[124:125], v[60:61]
    v_mov_b64 v[126:127], v[62:63]
    v_mov_b64 v[128:129], v[64:65]
    v_mov_b64 v[130:131], v[66:67]
    v_mov_b64 v[132:133], v[68:69]
    v_mov_b64 v[134:135], v[70:71]
K1_NXT2:
    s_cmp_eq_u32 s71, 3
    s_cbranch_scc1 K1_OWN3
    s_sub_u32 s72, s71, 4
    s_and_b32 s72, s72, 3
    s_lshl_b32 s72, s72, 11
    s_add_u32 s72, s72, s73
    v_add_u32 v11, s72, v12
    v_cvt_pk_bf16_f32 v160, v72, v73
    v_cvt_pk_bf16_f32 v161, v74, v75
    v_cvt_pk_bf16_f32 v162, v76, v77
    v_cvt_pk_bf16_f32 v163, v78, v79
    v_cvt_pk_bf16_f32 v164, v80, v81
    v_cvt_pk_bf16_f32 v165, v82, v83
    v_cvt_pk_bf16_f32 v166, v84, v85
    v_cvt_pk_bf16_f32 v167, v86, v87
    ds_write_b128 v11, v[160:163] offset:18432
    ds_write_b128 v11, v[164:167] offset:19456
    s_branch K1_NXT3
K1_OWN3:
    v_mov_b64 v[120:121], v[72:73]
    v_mov_b64 v[122:123], v[74:75]
    v_mov_b64 v[124:125], v[76:77]
    v_mov_b64 v[126:127], v[78:79]
    v_mov_b64 v[128:129], v[80:81]
    v_mov_b64 v[130:131], v[82:83]
    v_mov_b64 v[132:133], v[84:85]
    v_mov_b64 v[134:135], v[86:87]
K1_NXT3:
    s_waitcnt lgkmcnt(0)
    s_barrier
    v_mov_b32 v11, 64512
    ds_read_b128 v[136:139], v11 offset:0
    ds_read_b128 v[140:143], v11 offset:16
    ds_read_b128 v[144:147], v11 offset:32
    s_add_u32 s72, s71, 1
    s_and_b32 s72, s72, 3
    s_lshl_b32 s72, s72, 8
    v_add_u32 v11, s72, v10
    ds_read_b64 v[18:19], v11
    s_add_u32 s72, s71, 2
    s_and_b32 s72, s72, 3
    s_lshl_b32 s72, s72, 8
    v_add_u32 v11, s72, v10
    ds_read_b64 v[20:21], v11
    s_add_u32 s72, s71, 3
    s_and_b32 s72, s72, 3
    s_lshl_b32 s72, s72, 8
    v_add_u32 v11, s72, v10
    ds_read_b64 v[22:23], v11
    s_mul_i32 s72, s71, 6144
    s_add_u32 s72, s72, s73
    v_add_u32 v11, s72, v12
    ds_read_b128 v[24:27], v11 offset:0
    ds_read_b128 v[28:31], v11 offset:1024
    ds_read_b128 v[32:35], v11 offset:2048
    ds_read_b128 v[36:39], v11 offset:3072
    ds_read_b128 v[40:43], v11 offset:4096
    ds_read_b128 v[44:47], v11 offset:5120
    s_waitcnt lgkmcnt(6)
    v_or3_b32 v136, v136, v137, v138
    v_or3_b32 v139, v139, v140, v141
    v_or3_b32 v142, v142, v143, v144
    v_or3_b32 v145, v145, v146, v147
    v_or3_b32 v136, v136, v139, v142
    v_or_b32 v136, v136, v145
    v_cmp_ne_u32 vcc, 0, v136
    s_cbranch_vccnz K1_REDO
    v_max3_f32 v13, v16, v18, v20
    v_max_f32 v13, v13, v22
    v_sub_f32 v16, v16, v13
    v_sub_f32 v18, v18, v13
    v_sub_f32 v20, v20, v13
    v_sub_f32 v22, v22, v13
    v_exp_f32 v16, v16
    v_exp_f32 v18, v18
    v_exp_f32 v20, v20
    v_exp_f32 v22, v22
    s_nop 0
    v_mul_f32 v14, v16, v17
    v_fma_f32 v14, v18, v19, v14
    v_fma_f32 v14, v20, v21, v14
    v_fma_f32 v14, v22, v23, v14
    v_rcp_f32 v14, v14
    s_nop 0
    v_mul_f32 v16, v16, v14
    v_mul_f32 v18, v18, v14
    v_mul_f32 v20, v20, v14
    v_mul_f32 v22, v22, v14
    v_pk_mul_f32 v[120:121], v[120:121], v[16:17] op_sel_hi:[1,0]
    v_pk_mul_f32 v[122:123], v[122:123], v[16:17] op_sel_hi:[1,0]
    v_pk_mul_f32 v[124:125], v[124:125], v[16:17] op_sel_hi:[1,0]
    v_pk_mul_f32 v[126:127], v[126:127], v[16:17] op_sel_hi:[1,0]
    v_pk_mul_f32 v[128:129], v[128:129], v[16:17] op_sel_hi:[1,0]
    v_pk_mul_f32 v[130:131], v[130:131], v[16:17] op_sel_hi:[1,0]
    v_pk_mul_f32 v[132:133], v[132:133], v[16:17] op_sel_hi:[1,0]
    v_pk_mul_f32 v[134:135], v[134:135], v[16:17] op_sel_hi:[1,0]
    s_waitcnt lgkmcnt(4)
    v_lshlrev_b32 v56, 16, v24
    v_and_b32 v57, 0xffff0000, v24
    v_pk_fma_f32 v[120:121], v[56:57], v[18:19], v[120:121] op_sel_hi:[1,0,1]
    v_lshlrev_b32 v58, 16, v25
    v_and_b32 v59, 0xffff0000, v25
    v_pk_fma_f32 v[122:123], v[58:59], v[18:19], v[122:123] op_sel_hi:[1,0,1]
    v_lshlrev_b32 v60, 16, v26
    v_and_b32 v61, 0xffff0000, v26
    v_pk_fma_f32 v[124:125], v[60:61], v[18:19], v[124:125] op_sel_hi:[1,0,1]
    v_lshlrev_b32 v62, 16, v27
    v_and_b32 v63, 0xffff0000, v27
    v_pk_fma_f32 v[126:127], v[62:63], v[18:19], v[126:127] op_sel_hi:[1,0,1]
    v_lshlrev_b32 v56, 16, v28
    v_and_b32 v57, 0xffff0000, v28
    v_pk_fma_f32 v[128:129], v[56:57], v[18:19], v[128:129] op_sel_hi:[1,0,1]
    v_lshlrev_b32 v58, 16, v29
    v_and_b32 v59, 0xffff0000, v29
    v_pk_fma_f32 v[130:131], v[58:59], v[18:19], v[130:131] op_sel_hi:[1,0,1]
    v_lshlrev_b32 v60, 16, v30
    v_and_b32 v61, 0xffff0000, v30
    v_pk_fma_f32 v[132:133], v[60:61], v[18:19], v[132:133] op_sel_hi:[1,0,1]
    v_lshlrev_b32 v62, 16, v31
    v_and_b32 v63, 0xffff0000, v31
    v_pk_fma_f32 v[134:135], v[62:63], v[18:19], v[134:135] op_sel_hi:[1,0,1]
    s_waitcnt lgkmcnt(2)
    v_lshlrev_b32 v56, 16, v32
    v_and_b32 v57, 0xffff0000, v32
    v_pk_fma_f32 v[120:121], v[56:57], v[20:21], v[120:121] op_sel_hi:[1,0,1]
    v_lshlrev_b32 v58, 16, v33
    v_and_b32 v59, 0xffff0000, v33
    v_pk_fma_f32 v[122:123], v[58:59], v[20:21], v[122:123] op_sel_hi:[1,0,1]
    v_lshlrev_b32 v60, 16, v34
    v_and_b32 v61, 0xffff0000, v34
    v_pk_fma_f32 v[124:125], v[60:61], v[20:21], v[124:125] op_sel_hi:[1,0,1]
    v_lshlrev_b32 v62, 16, v35
    v_and_b32 v63, 0xffff0000, v35
    v_pk_fma_f32 v[126:127], v[62:63], v[20:21], v[126:127] op_sel_hi:[1,0,1]
    v_lshlrev_b32 v56, 16, v36
    v_and_b32 v57, 0xffff0000, v36
    v_pk_fma_f32 v[128:129], v[56:57], v[20:21], v[128:129] op_sel_hi:[1,0,1]
    v_lshlrev_b32 v58, 16, v37
    v_and_b32 v59, 0xffff0000, v37
    v_pk_fma_f32 v[130:131], v[58:59], v[20:21], v[130:131] op_sel_hi:[1,0,1]
    v_lshlrev_b32 v60, 16, v38
    v_and_b32 v61, 0xffff0000, v38
    v_pk_fma_f32 v[132:133], v[60:61], v[20:21], v[132:133] op_sel_hi:[1,0,1]
    v_lshlrev_b32 v62, 16, v39
    v_and_b32 v63, 0xffff0000, v39
    v_pk_fma_f32 v[134:135], v[62:63], v[20:21], v[134:135] op_sel_hi:[1,0,1]
    s_waitcnt lgkmcnt(0)
    v_lshlrev_b32 v56, 16, v40
    v_and_b32 v57, 0xffff0000, v40
    v_pk_fma_f32 v[120:121], v[56:57], v[22:23], v[120:121] op_sel_hi:[1,0,1]
    v_lshlrev_b32 v58, 16, v41
    v_and_b32 v59, 0xffff0000, v41
    v_pk_fma_f32 v[122:123], v[58:59], v[22:23], v[122:123] op_sel_hi:[1,0,1]
    v_lshlrev_b32 v60, 16, v42
    v_and_b32 v61, 0xffff0000, v42
    v_pk_fma_f32 v[124:125], v[60:61], v[22:23], v[124:125] op_sel_hi:[1,0,1]
    v_lshlrev_b32 v62, 16, v43
    v_and_b32 v63, 0xffff0000, v43
    v_pk_fma_f32 v[126:127], v[62:63], v[22:23], v[126:127] op_sel_hi:[1,0,1]
    v_lshlrev_b32 v56, 16, v44
    v_and_b32 v57, 0xffff0000, v44
    v_pk_fma_f32 v[128:129], v[56:57], v[22:23], v[128:129] op_sel_hi:[1,0,1]
    v_lshlrev_b32 v58, 16, v45
    v_and_b32 v59, 0xffff0000, v45
    v_pk_fma_f32 v[130:131], v[58:59], v[22:23], v[130:131] op_sel_hi:[1,0,1]
    v_lshlrev_b32 v60, 16, v46
    v_and_b32 v61, 0xffff0000, v46
    v_pk_fma_f32 v[132:133], v[60:61], v[22:23], v[132:133] op_sel_hi:[1,0,1]
    v_lshlrev_b32 v62, 16, v47
    v_and_b32 v63, 0xffff0000, v47
    v_pk_fma_f32 v[134:135], v[62:63], v[22:23], v[134:135] op_sel_hi:[1,0,1]
    v_cvt_pk_bf16_f32 v136, v120, v121
    v_cvt_pk_bf16_f32 v137, v122, v123
    v_cvt_pk_bf16_f32 v138, v124, v125
    v_cvt_pk_bf16_f32 v139, v126, v127
    v_cvt_pk_bf16_f32 v140, v128, v129
    v_cvt_pk_bf16_f32 v141, v130, v131
    v_cvt_pk_bf16_f32 v142, v132, v133
    v_cvt_pk_bf16_f32 v143, v134, v135
K1_COMB_DONE:
    v_mov_b32 v0, v15
    v_lshlrev_b32 v10, 4, v0
    s_lshl_b32 s72, s4, 11
    buffer_store_dwordx4 v[136:139], v10, s[24:27], s72 offen offset:0 sc1
    buffer_store_dwordx4 v[140:143], v10, s[24:27], s72 offen offset:1024 sc1
    s_cmp_ge_u32 s4, 8
    s_cbranch_scc1 O3_LOADER
    s_waitcnt vmcnt(0)
    s_barrier
    s_cmp_lg_u32 s4, 0
    s_cbranch_scc1 O3_NOFLAG
    s_lshl_b32 s20, s46, 2
    s_add_u32 s20, s20, s45
    v_mov_b32 v8, s96
    v_mov_b32 v9, s20
    s_mov_b64 exec, 1
    buffer_store_dword v8, v9, s[28:31], 0 offen sc1
    s_mov_b64 exec, -1
O3_NOFLAG:
    v_bfe_u32 v8, v0, 2, 2
    v_lshrrev_b32 v9, 4, v0
    v_and_b32 v10, 1, v9
    v_lshl_or_b32 v10, v10, 2, v8
    s_and_b32 s20, s4, 3
    s_lshl_b32 s20, s20, 1
    v_xor_b32 v10, s20, v10
    v_lshrrev_b32 v11, 1, v9
    v_lshlrev_b32 v11, 4, v11
    v_and_b32 v12, 1, v9
    v_lshl_add_u32 v11, v12, 2, v11
    v_add_u32 v11, v11, v8
    v_lshlrev_b32 v11, 8, v11
    v_lshl_add_u32 v11, v10, 5, v11
    v_and_b32 v12, 3, v0
    v_lshl_add_u32 v2, v12, 3, v11
    v_xor_b32 v3, 32, v2
    v_and_b32 v8, 15, v0
    v_mul_u32_u24 v10, 1536, v9
    v_lshl_add_u32 v10, v8, 4, v10
    s_lshr_b32 s20, s4, 2
    s_mul_i32 s20, s20, 768
    s_add_u32 s20, s20, 16384
    v_add_u32 v14, s20, v10
    v_mov_b64 v[104:105], 0
    v_mov_b64 v[106:107], 0
    v_mov_b64 v[108:109], 0
    v_mov_b64 v[110:111], 0
    v_mov_b64 v[112:113], 0
    v_mov_b64 v[114:115], 0
    v_mov_b64 v[116:117], 0
    v_mov_b64 v[118:119], 0
    v_mov_b64 v[120:121], 0
    v_mov_b64 v[122:123], 0
    v_mov_b64 v[124:125], 0
    v_mov_b64 v[126:127], 0
    s_mov_b32 s33, 0
    s_barrier
    s_barrier
    ds_read_b64_tr_b16 v[24:25], v2 offset:0
    ds_read_b64_tr_b16 v[26:27], v2 offset:2048
    ds_read_b64_tr_b16 v[32:33], v3 offset:0
    ds_read_b64_tr_b16 v[34:35], v3 offset:2048
    ds_read_b128 v[40:43], v14 offset:0
    ds_read_b128 v[48:51], v14 offset:256
    ds_read_b128 v[56:59], v14 offset:512
    ds_read_b64_tr_b16 v[28:29], v2 offset:8192
    ds_read_b64_tr_b16 v[30:31], v2 offset:10240
    ds_read_b64_tr_b16 v[36:37], v3 offset:8192
    ds_read_b64_tr_b16 v[38:39], v3 offset:10240
    ds_read_b128 v[44:47], v14 offset:6144
    ds_read_b128 v[52:55], v14 offset:6400
    ds_read_b128 v[60:63], v14 offset:6656
    s_add_u32 s20, s33, 28672
    s_cmp_ge_u32 s20, 143360
    s_cselect_b32 s21, 143360, 0
    s_sub_u32 s20, s20, s21
    s_sub_u32 s22, s20, s33
    s_mov_b32 s33, s20
    v_add_u32 v2, s22, v2
    v_add_u32 v3, s22, v3
    v_add_u32 v14, s22, v14
    s_waitcnt lgkmcnt(0)
    s_mov_b32 s32, 0
O3_C_LOOP:
    s_barrier
    v_mfma_f32_16x16x32_bf16 v[104:107], v[24:27], v[40:43], v[104:107]
    ds_read_b64_tr_b16 v[64:65], v2 offset:0
    ds_read_b64_tr_b16 v[66:67], v2 offset:2048
    v_mfma_f32_16x16x32_bf16 v[116:119], v[32:35], v[40:43], v[116:119]
    ds_read_b64_tr_b16 v[72:73], v3 offset:0
    v_mfma_f32_16x16x32_bf16 v[108:111], v[24:27], v[48:51], v[108:111]
    ds_read_b64_tr_b16 v[74:75], v3 offset:2048
    v_mfma_f32_16x16x32_bf16 v[120:123], v[32:35], v[48:51], v[120:123]
    ds_read_b128 v[80:83], v14 offset:0
    ds_read_b128 v[88:91], v14 offset:256
    v_mfma_f32_16x16x32_bf16 v[112:115], v[24:27], v[56:59], v[112:115]
    ds_read_b128 v[96:99], v14 offset:512
    v_mfma_f32_16x16x32_bf16 v[124:127], v[32:35], v[56:59], v[124:127]
    ds_read_b64_tr_b16 v[68:69], v2 offset:8192
    s_waitcnt lgkmcnt(8)
    v_mfma_f32_16x16x32_bf16 v[104:107], v[28:31], v[44:47], v[104:107]
    ds_read_b64_tr_b16 v[70:71], v2 offset:10240
    ds_read_b64_tr_b16 v[76:77], v3 offset:8192
    v_mfma_f32_16x16x32_bf16 v[116:119], v[36:39], v[44:47], v[116:119]
    ds_read_b64_tr_b16 v[78:79], v3 offset:10240
    v_mfma_f32_16x16x32_bf16 v[108:111], v[28:31], v[52:55], v[108:111]
    ds_read_b128 v[84:87], v14 offset:6144
    v_mfma_f32_16x16x32_bf16 v[120:123], v[36:39], v[52:55], v[120:123]
    ds_read_b128 v[92:95], v14 offset:6400
    ds_read_b128 v[100:103], v14 offset:6656
    v_mfma_f32_16x16x32_bf16 v[112:115], v[28:31], v[60:63], v[112:115]
    s_add_u32 s20, s33, 28672
    s_cmp_ge_u32 s20, 143360
    s_cselect_b32 s21, 143360, 0
    s_sub_u32 s20, s20, s21
    s_sub_u32 s22, s20, s33
    s_mov_b32 s33, s20
    v_add_u32 v2, s22, v2
    v_add_u32 v3, s22, v3
    v_add_u32 v14, s22, v14
    v_mfma_f32_16x16x32_bf16 v[124:127], v[36:39], v[60:63], v[124:127]
    s_waitcnt lgkmcnt(7)
    s_cmp_eq_u32 s32, 7
    s_cbranch_scc1 O3_C_DONE
    s_barrier
    v_mfma_f32_16x16x32_bf16 v[104:107], v[64:67], v[80:83], v[104:107]
    ds_read_b64_tr_b16 v[24:25], v2 offset:0
    ds_read_b64_tr_b16 v[26:27], v2 offset:2048
    v_mfma_f32_16x16x32_bf16 v[116:119], v[72:75], v[80:83], v[116:119]
    ds_read_b64_tr_b16 v[32:33], v3 offset:0
    v_mfma_f32_16x16x32_bf16 v[108:111], v[64:67], v[88:91], v[108:111]
    ds_read_b64_tr_b16 v[34:35], v3 offset:2048
    v_mfma_f32_16x16x32_bf16 v[120:123], v[72:75], v[88:91], v[120:123]
    ds_read_b128 v[40:43], v14 offset:0
    ds_read_b128 v[48:51], v14 offset:256
    v_mfma_f32_16x16x32_bf16 v[112:115], v[64:67], v[96:99], v[112:115]
    ds_read_b128 v[56:59], v14 offset:512
    v_mfma_f32_16x16x32_bf16 v[124:127], v[72:75], v[96:99], v[124:127]
    ds_read_b64_tr_b16 v[28:29], v2 offset:8192
    s_waitcnt lgkmcnt(8)
    v_mfma_f32_16x16x32_bf16 v[104:107], v[68:71], v[84:87], v[104:107]
    ds_read_b64_tr_b16 v[30:31], v2 offset:10240
    ds_read_b64_tr_b16 v[36:37], v3 offset:8192
    v_mfma_f32_16x16x32_bf16 v[116:119], v[76:79], v[84:87], v[116:119]
    ds_read_b64_tr_b16 v[38:39], v3 offset:10240
    v_mfma_f32_16x16x32_bf16 v[108:111], v[68:71], v[92:95], v[108:111]
    ds_read_b128 v[44:47], v14 offset:6144
    v_mfma_f32_16x16x32_bf16 v[120:123], v[76:79], v[92:95], v[120:123]
    ds_read_b128 v[52:55], v14 offset:6400
    ds_read_b128 v[60:63], v14 offset:6656
    v_mfma_f32_16x16x32_bf16 v[112:115], v[68:71], v[100:103], v[112:115]
    s_add_u32 s20, s33, 28672
    s_cmp_ge_u32 s20, 143360
    s_cselect_b32 s21, 143360, 0
    s_sub_u32 s20, s20, s21
    s_sub_u32 s22, s20, s33
    s_mov_b32 s33, s20
    v_add_u32 v2, s22, v2
    v_add_u32 v3, s22, v3
    v_add_u32 v14, s22, v14
    v_mfma_f32_16x16x32_bf16 v[124:127], v[76:79], v[100:103], v[124:127]
    s_waitcnt lgkmcnt(7)
    s_add_u32 s32, s32, 1
    s_branch O3_C_LOOP
O3_C_DONE:
    v_mfma_f32_16x16x32_bf16 v[104:107], v[64:67], v[80:83], v[104:107]
    v_mfma_f32_16x16x32_bf16 v[116:119], v[72:75], v[80:83], v[116:119]
    v_mfma_f32_16x16x32_bf16 v[108:111], v[64:67], v[88:91], v[108:111]
    v_mfma_f32_16x16x32_bf16 v[120:123], v[72:75], v[88:91], v[120:123]
    v_mfma_f32_16x16x32_bf16 v[112:115], v[64:67], v[96:99], v[112:115]
    v_mfma_f32_16x16x32_bf16 v[124:127], v[72:75], v[96:99], v[124:127]
    s_waitcnt lgkmcnt(0)
    v_mfma_f32_16x16x32_bf16 v[104:107], v[68:71], v[84:87], v[104:107]
    v_mfma_f32_16x16x32_bf16 v[116:119], v[76:79], v[84:87], v[116:119]
    v_mfma_f32_16x16x32_bf16 v[108:111], v[68:71], v[92:95], v[108:111]
    v_mfma_f32_16x16x32_bf16 v[120:123], v[76:79], v[92:95], v[120:123]
    v_mfma_f32_16x16x32_bf16 v[112:115], v[68:71], v[100:103], v[112:115]
    v_mfma_f32_16x16x32_bf16 v[124:127], v[76:79], v[100:103], v[124:127]
    s_sub_u32 s20, s47, 16384
    s_lshr_b32 s20, s20, 10
    s_lshl_b32 s20, s20, 3
    s_add_u32 s20, s20, s4
    s_mul_i32 s20, s20, 12288
    s_add_u32 s20, s20, 16777216
    s_add_u32 s24, s52, s20
    s_addc_u32 s25, s53, 0
    s_mov_b32 s26, 12288
    s_mov_b32 s27, 0x20000
    v_lshlrev_b32 v8, 4, v0
    s_lshl_b32 s21, s4, 7
    s_add_u32 s21, s21, s47
    s_and_b32 s39, s4, 3
    s_cmp_eq_u32 s39, s5
    s_cbranch_scc1 O3_LAST
    v_cvt_pk_bf16_f32 v24, v104, v105
    v_cvt_pk_bf16_f32 v25, v106, v107
    v_cvt_pk_bf16_f32 v26, v108, v109
    v_cvt_pk_bf16_f32 v27, v110, v111
    v_cvt_pk_bf16_f32 v28, v112, v113
    v_cvt_pk_bf16_f32 v29, v114, v115
    v_cvt_pk_bf16_f32 v30, v116, v117
    v_cvt_pk_bf16_f32 v31, v118, v119
    v_cvt_pk_bf16_f32 v32, v120, v121
    v_cvt_pk_bf16_f32 v33, v122, v123
    v_cvt_pk_bf16_f32 v34, v124, v125
    v_cvt_pk_bf16_f32 v35, v126, v127
    s_mul_i32 s20, s5, 3072
    buffer_store_dwordx4 v[24:27], v8, s[24:27], s20 offen offset:0 sc1
    buffer_store_dwordx4 v[28:31], v8, s[24:27], s20 offen offset:1024 sc1
    buffer_store_dwordx4 v[32:35], v8, s[24:27], s20 offen offset:2048 sc1
    s_lshl_b32 s20, s5, 2
    s_add_u32 s20, s20, s21
    v_mov_b32 v9, s96
    v_mov_b32 v10, s20
    s_waitcnt vmcnt(0)
    s_mov_b64 exec, 1
    buffer_store_dword v9, v10, s[28:31], 0 offen sc1
    s_mov_b64 exec, -1
    s_endpgm
O3_LAST:
    v_lshlrev_b32 v9, 2, v0
    v_add_u32 v9, s21, v9
    s_lshl_b32 s21, 1, s5
    s_xor_b32 s21, s21, 15
    s_mov_b64 exec, 15
    s_mov_b32 s32, 0
    buffer_load_dword v130, v9, s[28:31], 0 offen sc1
O3_PP2:
    s_waitcnt vmcnt(0)
    v_cmp_eq_u32 vcc, s96, v130
    s_nop 1
    s_and_b32 s22, vcc_lo, s21
    s_cmp_eq_u32 s22, s21
    s_cbranch_scc1 O3_PP2_OK
    s_sleep 2
    buffer_load_dword v130, v9, s[28:31], 0 offen sc1
    s_add_u32 s32, s32, 1
    s_cmp_lt_u32 s32, 100000
    s_cbranch_scc1 O3_PP2
O3_PP2_OK:
    s_mov_b64 exec, -1
    s_add_u32 s20, s5, 1
    s_and_b32 s20, s20, 3
    s_mul_i32 s20, s20, 3072
    buffer_load_dwordx4 v[24:27], v8, s[24:27], s20 offen offset:0 sc1
    buffer_load_dwordx4 v[28:31], v8, s[24:27], s20 offen offset:1024 sc1
    buffer_load_dwordx4 v[32:35], v8, s[24:27], s20 offen offset:2048 sc1
    s_add_u32 s20, s5, 2
    s_and_b32 s20, s20, 3
    s_mul_i32 s20, s20, 3072
    buffer_load_dwordx4 v[36:39], v8, s[24:27], s20 offen offset:0 sc1
    buffer_load_dwordx4 v[40:43], v8, s[24:27], s20 offen offset:1024 sc1
    buffer_load_dwordx4 v[44:47], v8, s[24:27], s20 offen offset:2048 sc1
    s_add_u32 s20, s5, 3
    s_and_b32 s20, s20, 3
    s_mul_i32 s20, s20, 3072
    buffer_load_dwordx4 v[48:51], v8, s[24:27], s20 offen offset:0 sc1
    buffer_load_dwordx4 v[52:55], v8, s[24:27], s20 offen offset:1024 sc1
    buffer_load_dwordx4 v[56:59], v8, s[24:27], s20 offen offset:2048 sc1
    s_lshr_b32 s20, s7, 1
    s_mul_i32 s20, s20, 96
    s_lshr_b32 s22, s4, 2
    s_mul_i32 s22, s22, 48
    s_add_u32 s20, s20, s22
    s_lshl_b32 s20, s20, 12
    s_lshl_b32 s22, s6, 11
    s_add_u32 s20, s20, s22
    s_lshl_b32 s22, s46, 8
    s_add_u32 s20, s20, s22
    s_and_b32 s22, s4, 3
    s_lshl_b32 s22, s22, 6
    s_add_u32 s20, s20, s22
    s_mov_b32 s16, s48
    s_mov_b32 s17, s49
    s_mov_b32 s18, 1572864
    s_mov_b32 s19, 0x20000
    v_and_b32 v9, 15, v0
    v_lshrrev_b32 v10, 4, v0
    v_lshlrev_b32 v9, 12, v9
    v_lshl_add_u32 v9, v10, 3, v9
    s_waitcnt vmcnt(8)
    v_lshlrev_b32 v60, 16, v24
    v_and_b32 v61, 0xffff0000, v24
    v_lshlrev_b32 v62, 16, v25
    v_and_b32 v63, 0xffff0000, v25
    v_lshlrev_b32 v64, 16, v26
    v_and_b32 v65, 0xffff0000, v26
    v_lshlrev_b32 v66, 16, v27
    v_and_b32 v67, 0xffff0000, v27
    v_pk_add_f32 v[104:105], v[104:105], v[60:61]
    v_pk_add_f32 v[106:107], v[106:107], v[62:63]
    v_pk_add_f32 v[108:109], v[108:109], v[64:65]
    v_pk_add_f32 v[110:111], v[110:111], v[66:67]
    s_waitcnt vmcnt(7)
    v_lshlrev_b32 v60, 16, v28
    v_and_b32 v61, 0xffff0000, v28
    v_lshlrev_b32 v62, 16, v29
    v_and_b32 v63, 0xffff0000, v29
    v_lshlrev_b32 v64, 16, v30
    v_and_b32 v65, 0xffff0000, v30
    v_lshlrev_b32 v66, 16, v31
    v_and_b32 v67, 0xffff0000, v31
    v_pk_add_f32 v[112:113], v[112:113], v[60:61]
    v_pk_add_f32 v[114:115], v[114:115], v[62:63]
    v_pk_add_f32 v[116:117], v[116:117], v[64:65]
    v_pk_add_f32 v[118:119], v[118:119], v[66:67]
    s_waitcnt vmcnt(6)
    v_lshlrev_b32 v60, 16, v32
    v_and_b32 v61, 0xffff0000, v32
    v_lshlrev_b32 v62, 16, v33
    v_and_b32 v63, 0xffff0000, v33
    v_lshlrev_b32 v64, 16, v34
    v_and_b32 v65, 0xffff0000, v34
    v_lshlrev_b32 v66, 16, v35
    v_and_b32 v67, 0xffff0000, v35
    v_pk_add_f32 v[120:121], v[120:121], v[60:61]
    v_pk_add_f32 v[122:123], v[122:123], v[62:63]
    v_pk_add_f32 v[124:125], v[124:125], v[64:65]
    v_pk_add_f32 v[126:127], v[126:127], v[66:67]
    s_waitcnt vmcnt(5)
    v_lshlrev_b32 v60, 16, v36
    v_and_b32 v61, 0xffff0000, v36
    v_lshlrev_b32 v62, 16, v37
    v_and_b32 v63, 0xffff0000, v37
    v_lshlrev_b32 v64, 16, v38
    v_and_b32 v65, 0xffff0000, v38
    v_lshlrev_b32 v66, 16, v39
    v_and_b32 v67, 0xffff0000, v39
    v_pk_add_f32 v[104:105], v[104:105], v[60:61]
    v_pk_add_f32 v[106:107], v[106:107], v[62:63]
    v_pk_add_f32 v[108:109], v[108:109], v[64:65]
    v_pk_add_f32 v[110:111], v[110:111], v[66:67]
    s_waitcnt vmcnt(4)
    v_lshlrev_b32 v60, 16, v40
    v_and_b32 v61, 0xffff0000, v40
    v_lshlrev_b32 v62, 16, v41
    v_and_b32 v63, 0xffff0000, v41
    v_lshlrev_b32 v64, 16, v42
    v_and_b32 v65, 0xffff0000, v42
    v_lshlrev_b32 v66, 16, v43
    v_and_b32 v67, 0xffff0000, v43
    v_pk_add_f32 v[112:113], v[112:113], v[60:61]
    v_pk_add_f32 v[114:115], v[114:115], v[62:63]
    v_pk_add_f32 v[116:117], v[116:117], v[64:65]
    v_pk_add_f32 v[118:119], v[118:119], v[66:67]
    s_waitcnt vmcnt(3)
    v_lshlrev_b32 v60, 16, v44
    v_and_b32 v61, 0xffff0000, v44
    v_lshlrev_b32 v62, 16, v45
    v_and_b32 v63, 0xffff0000, v45
    v_lshlrev_b32 v64, 16, v46
    v_and_b32 v65, 0xffff0000, v46
    v_lshlrev_b32 v66, 16, v47
    v_and_b32 v67, 0xffff0000, v47
    v_pk_add_f32 v[120:121], v[120:121], v[60:61]
    v_pk_add_f32 v[122:123], v[122:123], v[62:63]
    v_pk_add_f32 v[124:125], v[124:125], v[64:65]
    v_pk_add_f32 v[126:127], v[126:127], v[66:67]
    s_waitcnt vmcnt(2)
    v_lshlrev_b32 v60, 16, v48
    v_and_b32 v61, 0xffff0000, v48
    v_lshlrev_b32 v62, 16, v49
    v_and_b32 v63, 0xffff0000, v49
    v_lshlrev_b32 v64, 16, v50
    v_and_b32 v65, 0xffff0000, v50
    v_lshlrev_b32 v66, 16, v51
    v_and_b32 v67, 0xffff0000, v51
    v_pk_add_f32 v[104:105], v[104:105], v[60:61]
    v_pk_add_f32 v[106:107], v[106:107], v[62:63]
    v_pk_add_f32 v[108:109], v[108:109], v[64:65]
    v_pk_add_f32 v[110:111], v[110:111], v[66:67]
    s_waitcnt vmcnt(1)
    v_lshlrev_b32 v60, 16, v52
    v_and_b32 v61, 0xffff0000, v52
    v_lshlrev_b32 v62, 16, v53
    v_and_b32 v63, 0xffff0000, v53
    v_lshlrev_b32 v64, 16, v54
    v_and_b32 v65, 0xffff0000, v54
    v_lshlrev_b32 v66, 16, v55
    v_and_b32 v67, 0xffff0000, v55
    v_pk_add_f32 v[112:113], v[112:113], v[60:61]
    v_pk_add_f32 v[114:115], v[114:115], v[62:63]
    v_pk_add_f32 v[116:117], v[116:117], v[64:65]
    v_pk_add_f32 v[118:119], v[118:119], v[66:67]
    s_waitcnt vmcnt(0)
    v_lshlrev_b32 v60, 16, v56
    v_and_b32 v61, 0xffff0000, v56
    v_lshlrev_b32 v62, 16, v57
    v_and_b32 v63, 0xffff0000, v57
    v_lshlrev_b32 v64, 16, v58
    v_and_b32 v65, 0xffff0000, v58
    v_lshlrev_b32 v66, 16, v59
    v_and_b32 v67, 0xffff0000, v59
    v_pk_add_f32 v[120:121], v[120:121], v[60:61]
    v_pk_add_f32 v[122:123], v[122:123], v[62:63]
    v_pk_add_f32 v[124:125], v[124:125], v[64:65]
    v_pk_add_f32 v[126:127], v[126:127], v[66:67]
    v_cvt_pk_bf16_f32 v104, v104, v105
    v_cvt_pk_bf16_f32 v105, v106, v107
    s_add_u32 s22, s20, 0
    buffer_store_dwordx2 v[104:105], v9, s[16:19], s22 offen offset:0 nt
    v_cvt_pk_bf16_f32 v108, v108, v109
    v_cvt_pk_bf16_f32 v109, v110, v111
    s_add_u32 s22, s20, 65536
    buffer_store_dwordx2 v[108:109], v9, s[16:19], s22 offen offset:0 nt
    v_cvt_pk_bf16_f32 v112, v112, v113
    v_cvt_pk_bf16_f32 v113, v114, v115
    s_add_u32 s22, s20, 131072
    buffer_store_dwordx2 v[112:113], v9, s[16:19], s22 offen offset:0 nt
    v_cvt_pk_bf16_f32 v116, v116, v117
    v_cvt_pk_bf16_f32 v117, v118, v119
    s_add_u32 s22, s20, 0
    buffer_store_dwordx2 v[116:117], v9, s[16:19], s22 offen offset:32 nt
    v_cvt_pk_bf16_f32 v120, v120, v121
    v_cvt_pk_bf16_f32 v121, v122, v123
    s_add_u32 s22, s20, 65536
    buffer_store_dwordx2 v[120:121], v9, s[16:19], s22 offen offset:32 nt
    v_cvt_pk_bf16_f32 v124, v124, v125
    v_cvt_pk_bf16_f32 v125, v126, v127
    s_add_u32 s22, s20, 131072
    buffer_store_dwordx2 v[124:125], v9, s[16:19], s22 offen offset:32 nt
    s_endpgm
O3_LOADER:
    s_cmp_eq_u32 s6, 0
    s_cselect_b64 s[12:13], s[36:37], s[50:51]
    s_lshl_b32 s20, s5, 21
    s_lshl_b32 s21, s46, 8
    s_add_u32 s20, s20, s21
    s_add_u32 s12, s12, s20
    s_addc_u32 s13, s13, 0
    s_sub_u32 s14, 2097152, s21
    s_mov_b32 s15, 0x20000
    s_lshl_b32 s20, s6, 2
    s_add_u32 s20, s20, s5
    s_lshl_b32 s20, s20, 3
    s_and_b32 s21, s7, 6
    s_add_u32 s20, s20, s21
    s_mul_i32 s20, s20, 98304
    s_add_u32 s8, s52, s20
    s_addc_u32 s9, s53, 0
    s_mov_b32 s10, 196608
    s_mov_b32 s11, 0x20000
    s_sub_u32 s23, s4, 8
    v_lshrrev_b32 v8, 4, v0
    v_and_b32 v9, 15, v0
    s_and_b32 s20, s23, 1
    s_lshl_b32 s21, s20, 2
    v_or_b32 v10, s21, v8
    v_lshlrev_b32 v10, 1, v10
    v_xor_b32 v10, v9, v10
    v_lshlrev_b32 v10, 4, v10
    v_lshl_add_u32 v20, v8, 11, v10
    s_mov_b32 s20, s23
    s_lshl_b32 s21, s20, 13
    v_add_u32 v20, s21, v20
    s_lshl_b32 s33, s20, 10
    s_add_u32 s22, s33, 143360
    s_lshl_b32 s35, s3, 19
    s_mov_b32 s32, 0
O3_LP0:
    s_add_u32 m0, s33, 0
    s_add_u32 s20, s35, 0
    buffer_load_dwordx4 v20, s[12:15], s20 offen lds
    s_add_u32 m0, s33, 4096
    s_add_u32 s20, s35, 32768
    buffer_load_dwordx4 v20, s[12:15], s20 offen lds
    s_add_u32 m0, s33, 8192
    s_add_u32 s20, s35, 65536
    buffer_load_dwordx4 v20, s[12:15], s20 offen lds
    s_add_u32 m0, s33, 12288
    s_add_u32 s20, s35, 98304
    buffer_load_dwordx4 v20, s[12:15], s20 offen lds
    s_add_u32 s33, s33, 28672
    s_cmp_ge_u32 s33, s22
    s_cselect_b32 s21, 143360, 0
    s_sub_u32 s33, s33, s21
    s_add_u32 s35, s35, 131072
    s_and_b32 s35, s35, 0x1fffff
    s_add_u32 s32, s32, 1
    s_cmp_lt_u32 s32, 2
    s_cbranch_scc1 O3_LP0
    s_lshr_b32 s20, s23, 1
    s_lshl_b32 s20, s20, 11
    s_and_b32 s21, s23, 1
    s_lshl_b32 s21, s21, 10
    s_add_u32 s20, s20, s21
    v_mov_b32 v8, v0
    v_mov_b32 v9, s20
    v_cmp_le_u32 vcc, 48, v8
    v_subrev_u32 v10, 48, v8
    v_cndmask_b32 v8, v8, v10, vcc
    v_add_u32 v10, 98304, v9
    v_cndmask_b32 v9, v9, v10, vcc
    v_add_u32 v10, 0, v8
    v_lshrrev_b32 v11, 5, v10
    v_and_b32 v10, 31, v10
    v_lshl_add_u32 v10, v10, 4, v9
    v_lshl_add_u32 v24, v11, 13, v10
    v_add_u32 v10, 48, v8
    v_lshrrev_b32 v11, 5, v10
    v_and_b32 v10, 31, v10
    v_lshl_add_u32 v10, v10, 4, v9
    v_lshl_add_u32 v27, v11, 13, v10
    v_cmp_gt_u32 vcc, 32, v0
    v_add_u32 v10, 64, v0
    v_subrev_u32 v11, 32, v0
    v_cndmask_b32 v8, v11, v10, vcc
    v_mov_b32 v10, 512
    v_cndmask_b32 v9, v10, 0, vcc
    v_add_u32 v9, s20, v9
    v_cmp_le_u32 vcc, 48, v8
    v_subrev_u32 v10, 48, v8
    v_cndmask_b32 v8, v8, v10, vcc
    v_add_u32 v10, 98304, v9
    v_cndmask_b32 v9, v9, v10, vcc
    v_add_u32 v10, 0, v8
    v_lshrrev_b32 v11, 5, v10
    v_and_b32 v10, 31, v10
    v_lshl_add_u32 v10, v10, 4, v9
    v_lshl_add_u32 v25, v11, 13, v10
    v_add_u32 v10, 48, v8
    v_lshrrev_b32 v11, 5, v10
    v_and_b32 v10, 31, v10
    v_lshl_add_u32 v10, v10, 4, v9
    v_lshl_add_u32 v28, v11, 13, v10
    v_add_u32 v8, 32, v0
    v_mov_b32 v9, 512
    v_add_u32 v9, s20, v9
    v_cmp_le_u32 vcc, 48, v8
    v_subrev_u32 v10, 48, v8
    v_cndmask_b32 v8, v8, v10, vcc
    v_add_u32 v10, 98304, v9
    v_cndmask_b32 v9, v9, v10, vcc
    v_add_u32 v10, 0, v8
    v_lshrrev_b32 v11, 5, v10
    v_and_b32 v10, 31, v10
    v_lshl_add_u32 v10, v10, 4, v9
    v_lshl_add_u32 v26, v11, 13, v10
    v_add_u32 v10, 48, v8
    v_lshrrev_b32 v11, 5, v10
    v_and_b32 v10, 31, v10
    v_lshl_add_u32 v10, v10, 4, v9
    v_lshl_add_u32 v29, v11, 13, v10
    s_mul_i32 s34, s23, 3072
    s_mov_b32 s38, 0
    s_add_u32 s40, s34, 143360
    s_waitcnt vmcnt(8)
    s_barrier
    s_mov_b32 s32, 0
O3_LP1:
    s_add_u32 m0, s33, 0
    s_add_u32 s20, s35, 0
    buffer_load_dwordx4 v20, s[12:15], s20 offen lds
    s_add_u32 m0, s33, 4096
    s_add_u32 s20, s35, 32768
    buffer_load_dwordx4 v20, s[12:15], s20 offen lds
    s_add_u32 m0, s33, 8192
    s_add_u32 s20, s35, 65536
    buffer_load_dwordx4 v20, s[12:15], s20 offen lds
    s_add_u32 m0, s33, 12288
    s_add_u32 s20, s35, 98304
    buffer_load_dwordx4 v20, s[12:15], s20 offen lds
    s_add_u32 s33, s33, 28672
    s_cmp_ge_u32 s33, s22
    s_cselect_b32 s21, 143360, 0
    s_sub_u32 s33, s33, s21
    s_add_u32 s35, s35, 131072
    s_and_b32 s35, s35, 0x1fffff
    s_add_u32 s32, s32, 1
    s_cmp_lt_u32 s32, 3
    s_cbranch_scc1 O3_LP1
    s_cmp_lg_u32 s4, 8
    s_cbranch_scc1 O3_POLL_DONE
    v_lshlrev_b32 v23, 2, v0
    v_add_u32 v23, s45, v23
    s_mov_b64 exec, 0xff
    s_mov_b32 s32, 0
O3_POLL1:
    buffer_load_dword v22, v23, s[28:31], 0 offen sc1
    s_waitcnt vmcnt(0)
    v_cmp_eq_u32 vcc, s96, v22
    s_nop 1
    s_cmp_eq_u32 vcc_lo, 0xff
    s_cbranch_scc1 O3_POLL_OK
    s_sleep 2
    s_add_u32 s32, s32, 1
    s_cmp_lt_u32 s32, 400000
    s_cbranch_scc1 O3_POLL1
O3_POLL_OK:
    s_mov_b64 exec, -1
O3_POLL_DONE:
    s_barrier
    s_mov_b32 s32, 0
O3_LP2:
    s_bitcmp1_b32 s38, 1
    s_cselect_b64 vcc, -1, 0
    s_lshr_b32 s20, s38, 2
    s_add_u32 s20, s20, s3
    s_and_b32 s20, s20, 3
    s_mul_i32 s20, s20, 24576
    s_and_b32 s21, s38, 1
    s_lshl_b32 s21, s21, 12
    s_add_u32 s20, s20, s21
    v_cndmask_b32 v30, v24, v27, vcc
    v_cndmask_b32 v31, v25, v28, vcc
    v_cndmask_b32 v32, v26, v29, vcc
    s_add_u32 m0, s34, 16384
    s_nop 0
    buffer_load_dwordx4 v30, s[8:11], s20 offen sc1 lds
    s_add_u32 m0, s34, 17408
    s_nop 0
    buffer_load_dwordx4 v31, s[8:11], s20 offen sc1 lds
    s_add_u32 m0, s34, 18432
    s_nop 0
    buffer_load_dwordx4 v32, s[8:11], s20 offen sc1 lds
    s_add_u32 s34, s34, 28672
    s_cmp_ge_u32 s34, s40
    s_cselect_b32 s21, 143360, 0
    s_sub_u32 s34, s34, s21
    s_add_u32 s38, s38, 1
    s_add_u32 s32, s32, 1
    s_cmp_lt_u32 s32, 5
    s_cbranch_scc1 O3_LP2
    s_waitcnt vmcnt(12)
    s_barrier
    s_waitcnt vmcnt(9)
    s_barrier
    s_waitcnt vmcnt(6)
    s_barrier
    s_add_u32 m0, s33, 0
    s_add_u32 s20, s35, 0
    buffer_load_dwordx4 v20, s[12:15], s20 offen lds
    s_add_u32 m0, s33, 4096
    s_add_u32 s20, s35, 32768
    buffer_load_dwordx4 v20, s[12:15], s20 offen lds
    s_add_u32 m0, s33, 8192
    s_add_u32 s20, s35, 65536
    buffer_load_dwordx4 v20, s[12:15], s20 offen lds
    s_add_u32 m0, s33, 12288
    s_add_u32 s20, s35, 98304
    buffer_load_dwordx4 v20, s[12:15], s20 offen lds
    s_add_u32 s33, s33, 28672
    s_cmp_ge_u32 s33, s22
    s_cselect_b32 s21, 143360, 0
    s_sub_u32 s33, s33, s21
    s_add_u32 s35, s35, 131072
    s_and_b32 s35, s35, 0x1fffff
    s_bitcmp1_b32 s38, 1
    s_cselect_b64 vcc, -1, 0
    s_lshr_b32 s20, s38, 2
    s_add_u32 s20, s20, s3
    s_and_b32 s20, s20, 3
    s_mul_i32 s20, s20, 24576
    s_and_b32 s21, s38, 1
    s_lshl_b32 s21, s21, 12
    s_add_u32 s20, s20, s21
    v_cndmask_b32 v30, v24, v27, vcc
    v_cndmask_b32 v31, v25, v28, vcc
    v_cndmask_b32 v32, v26, v29, vcc
    s_add_u32 m0, s34, 16384
    s_nop 0
    buffer_load_dwordx4 v30, s[8:11], s20 offen sc1 lds
    s_add_u32 m0, s34, 17408
    s_nop 0
    buffer_load_dwordx4 v31, s[8:11], s20 offen sc1 lds
    s_add_u32 m0, s34, 18432
    s_nop 0
    buffer_load_dwordx4 v32, s[8:11], s20 offen sc1 lds
    s_add_u32 s34, s34, 28672
    s_cmp_ge_u32 s34, s40
    s_cselect_b32 s21, 143360, 0
    s_sub_u32 s34, s34, s21
    s_add_u32 s38, s38, 1
    s_waitcnt vmcnt(10)
    s_barrier
    s_add_u32 m0, s33, 0
    s_add_u32 s20, s35, 0
    buffer_load_dwordx4 v20, s[12:15], s20 offen lds
    s_add_u32 m0, s33, 4096
    s_add_u32 s20, s35, 32768
    buffer_load_dwordx4 v20, s[12:15], s20 offen lds
    s_add_u32 m0, s33, 8192
    s_add_u32 s20, s35, 65536
    buffer_load_dwordx4 v20, s[12:15], s20 offen lds
    s_add_u32 m0, s33, 12288
    s_add_u32 s20, s35, 98304
    buffer_load_dwordx4 v20, s[12:15], s20 offen lds
    s_add_u32 s33, s33, 28672
    s_cmp_ge_u32 s33, s22
    s_cselect_b32 s21, 143360, 0
    s_sub_u32 s33, s33, s21
    s_add_u32 s35, s35, 131072
    s_and_b32 s35, s35, 0x1fffff
    s_bitcmp1_b32 s38, 1
    s_cselect_b64 vcc, -1, 0
    s_lshr_b32 s20, s38, 2
    s_add_u32 s20, s20, s3
    s_and_b32 s20, s20, 3
    s_mul_i32 s20, s20, 24576
    s_and_b32 s21, s38, 1
    s_lshl_b32 s21, s21, 12
    s_add_u32 s20, s20, s21
    v_cndmask_b32 v30, v24, v27, vcc
    v_cndmask_b32 v31, v25, v28, vcc
    v_cndmask_b32 v32, v26, v29, vcc
    s_add_u32 m0, s34, 16384
    s_nop 0
    buffer_load_dwordx4 v30, s[8:11], s20 offen sc1 lds
    s_add_u32 m0, s34, 17408
    s_nop 0
    buffer_load_dwordx4 v31, s[8:11], s20 offen sc1 lds
    s_add_u32 m0, s34, 18432
    s_nop 0
    buffer_load_dwordx4 v32, s[8:11], s20 offen sc1 lds
    s_add_u32 s34, s34, 28672
    s_cmp_ge_u32 s34, s40
    s_cselect_b32 s21, 143360, 0
    s_sub_u32 s34, s34, s21
    s_add_u32 s38, s38, 1
    s_mov_b32 s32, 3
O3_L_LOOP:
    s_waitcnt vmcnt(14)
    s_barrier
    s_add_u32 m0, s33, 0
    s_add_u32 s20, s35, 0
    buffer_load_dwordx4 v20, s[12:15], s20 offen lds
    s_add_u32 m0, s33, 4096
    s_add_u32 s20, s35, 32768
    buffer_load_dwordx4 v20, s[12:15], s20 offen lds
    s_add_u32 m0, s33, 8192
    s_add_u32 s20, s35, 65536
    buffer_load_dwordx4 v20, s[12:15], s20 offen lds
    s_add_u32 m0, s33, 12288
    s_add_u32 s20, s35, 98304
    buffer_load_dwordx4 v20, s[12:15], s20 offen lds
    s_add_u32 s33, s33, 28672
    s_cmp_ge_u32 s33, s22
    s_cselect_b32 s21, 143360, 0
    s_sub_u32 s33, s33, s21
    s_add_u32 s35, s35, 131072
    s_and_b32 s35, s35, 0x1fffff
    s_bitcmp1_b32 s38, 1
    s_cselect_b64 vcc, -1, 0
    s_lshr_b32 s20, s38, 2
    s_add_u32 s20, s20, s3
    s_and_b32 s20, s20, 3
    s_mul_i32 s20, s20, 24576
    s_and_b32 s21, s38, 1
    s_lshl_b32 s21, s21, 12
    s_add_u32 s20, s20, s21
    v_cndmask_b32 v30, v24, v27, vcc
    v_cndmask_b32 v31, v25, v28, vcc
    v_cndmask_b32 v32, v26, v29, vcc
    s_add_u32 m0, s34, 16384
    s_nop 0
    buffer_load_dwordx4 v30, s[8:11], s20 offen sc1 lds
    s_add_u32 m0, s34, 17408
    s_nop 0
    buffer_load_dwordx4 v31, s[8:11], s20 offen sc1 lds
    s_add_u32 m0, s34, 18432
    s_nop 0
    buffer_load_dwordx4 v32, s[8:11], s20 offen sc1 lds
    s_add_u32 s34, s34, 28672
    s_cmp_ge_u32 s34, s40
    s_cselect_b32 s21, 143360, 0
    s_sub_u32 s34, s34, s21
    s_add_u32 s38, s38, 1
    s_add_u32 s32, s32, 1
    s_cmp_lt_u32 s32, 12
    s_cbranch_scc1 O3_L_LOOP
    s_waitcnt vmcnt(14)
    s_barrier
    s_waitcnt vmcnt(7)
    s_barrier
    s_waitcnt vmcnt(0)
    s_barrier
K1_END:
    s_endpgm
.section .rodata,"a"
.p2align 6
.amdhsa_kernel concat_heads__gqa_block_cached__gqa_block_cached__near_ridge_kernel
  .amdhsa_next_free_vgpr 168
  .amdhsa_next_free_sgpr 102
  .amdhsa_accum_offset 168
  .amdhsa_group_segment_fixed_size 0
  .amdhsa_kernarg_size 104
  .amdhsa_user_sgpr_count 2
  .amdhsa_user_sgpr_kernarg_segment_ptr 1
  .amdhsa_system_sgpr_workgroup_id_x 1
.end_amdhsa_kernel
```
